```python
import torch

def _softmax(x, axis=-1):
    return torch.softmax(x, dim=axis)
def _gelu(x):
    return torch.nn.functional.gelu(x, approximate="tanh")
def _silu(x):
    return torch.nn.functional.silu(x)
def _sigmoid(x):
    return torch.sigmoid(x)
def _layernorm(x, axis=-1, eps=1e-5):
    m = x.mean(dim=axis, keepdim=True)
    v = x.var(dim=axis, keepdim=True, unbiased=False)
    return (x - m) / torch.sqrt(v + eps)
def _scatter_add(tgt, idx, src, axis=0):
    return tgt.clone().index_add_(axis, idx, src)
def _segment_sum(src, seg, n):
    out = torch.zeros((n,) + src.shape[1:], dtype=src.dtype)
    return out.index_add_(0, seg, src)
def _pad(x, pw):
    flat = tuple(v for pair in reversed(pw) for v in pair)
    return torch.nn.functional.pad(x, flat)

kernel_name = 'recurrent_scan__ssm_conv_s4__swiglu_ffn__prompt'

def setup_inputs():

    _w = (lambda a: (lambda t: t.to(torch.bfloat16) if t.is_floating_point() else t)(torch.as_tensor(a)))
    def _A_setup():
        B, L, D, N = 1, 2048, 512, 128
        A_re = -(lambda _x: torch.exp(torch.as_tensor(_x)))((lambda *s: torch.randn(*s, dtype=torch.bfloat16) * 3.2)(D, N))
        A_im = torch.pi * (lambda *s: torch.randn(*s, dtype=torch.bfloat16) * 0.05)(D, N)
        B_re = (lambda *s: torch.randn(*s, dtype=torch.bfloat16) * 0.1)(D, N)
        B_im = (lambda *s: torch.randn(*s, dtype=torch.bfloat16) * 0.1)(D, N)
        C_re = (lambda *s: torch.randn(*s, dtype=torch.bfloat16) * 0.1)(D, N)
        C_im = (lambda *s: torch.randn(*s, dtype=torch.bfloat16) * 0.1)(D, N)
        log_dt = (lambda *s: torch.randn(*s, dtype=torch.bfloat16) * 0.05)(D) * 0.5 - 4.0
        Dskip = (lambda *s: torch.randn(*s, dtype=torch.bfloat16) * 0.05)(D)
        return {
            "u": _w((lambda *s: torch.randn(*s, dtype=torch.bfloat16) * 0.05)(B, L, D)),
            "A_re": _w(A_re),
            "A_im": _w(A_im),
            "B_re": _w(B_re),
            "B_im": _w(B_im),
            "C_re": _w(C_re),
            "C_im": _w(C_im),
            "log_dt": _w(log_dt),
            "Dskip": _w(Dskip),
        }
    _A_in = _A_setup()

    def _B_setup():
        B, S, D, F = 1, 2048, 512, 1792
        return {
            "x": _w((lambda *s: torch.randn(*s, dtype=torch.bfloat16) * 0.05)(B, S, D)),
            "w_gate": _w((lambda *s: torch.randn(*s, dtype=torch.bfloat16) * 0.05)(D, F)),
            "w_up": _w((lambda *s: torch.randn(*s, dtype=torch.bfloat16) * 0.05)(D, F)),
            "w_down": _w((lambda *s: torch.randn(*s, dtype=torch.bfloat16) * 0.05)(F, D)),
        }
    _B_in = _B_setup()

    return {
        "A_u": _A_in["u"],
        "A_A_re": _A_in["A_re"],
        "A_A_im": _A_in["A_im"],
        "A_B_re": _A_in["B_re"],
        "A_B_im": _A_in["B_im"],
        "A_C_re": _A_in["C_re"],
        "A_C_im": _A_in["C_im"],
        "A_log_dt": _A_in["log_dt"],
        "A_Dskip": _A_in["Dskip"],
        "B_x": _B_in["x"],
        "B_w_gate": _B_in["w_gate"],
        "B_w_up": _B_in["w_up"],
        "B_w_down": _B_in["w_down"],
    }

def reference(A_u, A_A_re, A_A_im, A_B_re, A_B_im, A_C_re, A_C_im, A_log_dt, A_Dskip, B_x, B_w_gate, B_w_up, B_w_down):
    def _A_ref(u, A_re, A_im, B_re, B_im, C_re, C_im, log_dt, Dskip):
        Bsz, L, D = u.shape
        dt = torch.exp(log_dt)[:, None]
        A = A_re + 1j * A_im
        Bc = B_re + 1j * B_im
        Cc = C_re + 1j * C_im
        logdA = dt * A
        dB = dt * Bc
        l = (lambda x, dt: x.to(dt))(torch.arange(L), A_re.dtype)
        P = torch.exp(logdA[:, :, None] * l[None, None, :])
        K = torch.einsum("dn,dnl,dn->dl", Cc, P, dB).real
        L2 = 2 * L
        Kp = _pad(K, ((0, 0), (0, L)))
        up = (lambda x, *d: x.permute(*d))(u, 0, 2, 1)
        up = _pad(up, ((0, 0), (0, 0), (0, L)))
        Kf = (lambda x, axes=(-2,-1): torch.fft.rfft2(x.float(), dim=axes))(Kp[:, None, :], axes=(-2, -1))
        Uf = (lambda x, axes=(-2,-1): torch.fft.rfft2(x.float(), dim=axes))(up[:, :, None, :], axes=(-2, -1))
        Yf = Uf * Kf[None, :, :, :]
        y = (lambda x, s, axes=(-2,-1): torch.fft.irfft2(x, s=s, dim=axes).to(torch.bfloat16))(Yf, (1, L2), axes=(-2, -1))[:, :, 0, :L]
        y = (lambda x, *d: x.permute(*d))(y, 0, 2, 1) + u * Dskip[None, None, :]
        return y

    def _B_ref(x, w_gate, w_up, w_down):
        g = _silu(x @ w_gate)
        u = x @ w_up
        return (g * u) @ w_down

    x = A_u
    xn = _layernorm(x, axis=-1)
    s = _A_ref(xn, A_A_re, A_A_im, A_B_re, A_B_im, A_C_re, A_C_im, A_log_dt, A_Dskip)
    g = _silu(_B_ref(xn, B_w_gate, B_w_up, B_w_down))
    return x + s * g
```

```asm
; @launch grid=(256,1,1) block=(512,1,1) lds=163840
.amdgcn_target "amdgcn-amd-amdhsa--gfx950"
.text
.globl recurrent_scan__ssm_conv_s4__swiglu_ffn__prompt_kernel
.p2align 8
.type recurrent_scan__ssm_conv_s4__swiglu_ffn__prompt_kernel,@function
recurrent_scan__ssm_conv_s4__swiglu_ffn__prompt_kernel:
    s_cmp_ge_u32 s2, 256
    s_cbranch_scc1 F_END
    s_getpc_b64 s[4:5]
F_PC:
    v_lshlrev_b32 v2, 7, v0
    v_min_u32 v2, (F_CODE_END-F_PC-4)&0xffffff80, v2
    v_mov_b32 v3, s5
    v_add_co_u32 v2, vcc, s4, v2
    s_nop 1
    v_addc_co_u32 v3, vcc, 0, v3, vcc
    global_load_dword v7, v[2:3], off
    v_lshrrev_b32 v2, 6, v0
    v_and_b32 v1, 63, v0
    v_readfirstlane_b32 s3, v2
    v_mov_b32 v5, 163712
    s_cmp_ge_u32 s3, 4
    s_cbranch_scc1 F_H
    s_load_dwordx2 s[4:5], s[0:1], 0
    s_load_dwordx2 s[6:7], s[0:1], 120
    s_load_dwordx4 s[48:51], s[0:1], 80
    s_load_dwordx4 s[8:11], s[0:1], 96
    s_and_b32 s32, s2, 1
    s_lshl_b32 s32, s32, 3
    s_lshr_b32 s33, s2, 3
    s_and_b32 s28, s33, 7
    s_add_u32 s28, s28, s32
    s_bfe_u32 s32, s2, 131073
    s_lshl_b32 s32, s32, 2
    s_lshr_b32 s29, s2, 6
    s_add_u32 s29, s29, s32
    s_and_b32 s32, s2, 7
    s_lshl_b32 s32, s32, 2
    s_bfe_u32 s30, s2, 131075
    s_add_u32 s30, s30, s32
    s_lshr_b32 s31, s2, 5
    s_mov_b32 s36, 0xffff0000
    s_and_b32 s38, s3, 1
    s_lshr_b32 s39, s3, 1
    v_lshlrev_b32 v127, 4, v1
    v_and_b32 v2, 7, v1
    v_min_u32 v2, 6, v2
    v_lshlrev_b32 v2, 4, v2
    v_lshrrev_b32 v3, 3, v1
    v_mul_u32_u24 v3, 3584, v3
    v_add_u32 v153, v2, v3
    s_lshl_b32 s32, s2, 13
    s_lshl_b32 s33, s3, 11
    s_add_u32 s34, s32, s33
    s_mul_i32 s32, s28, 114688
    s_mul_i32 s33, s29, 224
    s_add_u32 s32, s32, s33
    s_mul_i32 s33, s38, 112
    s_add_u32 s35, s32, s33
    s_and_b32 s37, s3, 1
    s_lshl_b32 s37, s37, 2
    v_lshrrev_b32 v2, 4, v1
    v_add_u32 v2, s37, v2
    v_and_b32 v3, 7, v1
    v_xor_b32 v2, v2, v3
    v_lshlrev_b32 v2, 4, v2
    v_lshrrev_b32 v3, 3, v1
    v_lshl_add_u32 v154, v3, 10, v2
    s_lshl_b32 s37, s3, 6
    v_add_u32 v2, s37, v1
    v_mul_u32_u24 v3, 4370, v2
    v_lshrrev_b32 v3, 16, v3
    v_mul_u32_u24 v4, 15, v3
    v_sub_u32 v4, v2, v4
    v_min_u32 v4, 13, v4
    v_mul_u32_u24 v3, 3584, v3
    v_lshl_add_u32 v155, v4, 4, v3
    v_add_u32 v2, s37, v1
    v_add_u32 v2, 256, v2
    v_mul_u32_u24 v3, 4370, v2
    v_lshrrev_b32 v3, 16, v3
    v_mul_u32_u24 v4, 15, v3
    v_sub_u32 v4, v2, v4
    v_min_u32 v4, 13, v4
    v_mul_u32_u24 v3, 3584, v3
    v_lshl_add_u32 v156, v4, 4, v3
    v_add_u32 v2, s37, v1
    v_add_u32 v2, 512, v2
    v_mul_u32_u24 v3, 4370, v2
    v_lshrrev_b32 v3, 16, v3
    v_mul_u32_u24 v4, 15, v3
    v_sub_u32 v4, v2, v4
    v_min_u32 v4, 13, v4
    v_mul_u32_u24 v3, 3584, v3
    v_lshl_add_u32 v157, v4, 4, v3
    v_add_u32 v2, s37, v1
    v_add_u32 v2, 768, v2
    v_mul_u32_u24 v3, 4370, v2
    v_lshrrev_b32 v3, 16, v3
    v_mul_u32_u24 v4, 15, v3
    v_sub_u32 v4, v2, v4
    v_min_u32 v4, 13, v4
    v_mul_u32_u24 v3, 3584, v3
    v_lshl_add_u32 v158, v4, 4, v3
    s_cmp_eq_u32 s3, 3
    s_cselect_b64 s[60:61], 0, -1
    s_lshl_b32 s58, s28, 17
    s_lshl_b32 s37, s3, 13
    s_add_u32 s58, s58, s37
    s_mul_i32 s59, s29, 224
    s_lshl_b32 s47, s3, 10
    v_mov_b32 v2, 0
    s_waitcnt lgkmcnt(0)
    s_mov_b32 s12, s4
    s_and_b32 s13, s5, 65535
    s_mov_b32 s14, 0x200000
    s_mov_b32 s15, 0x20000
    s_mov_b32 s16, s6
    s_and_b32 s17, s7, 65535
    s_mov_b32 s18, 0xe00000
    s_mov_b32 s19, 0x20000
    s_mov_b32 s20, s48
    s_and_b32 s21, s49, 65535
    s_mov_b32 s22, 0x1c0000
    s_mov_b32 s23, 0x20000
    s_mov_b32 s24, s50
    s_and_b32 s25, s51, 65535
    s_mov_b32 s26, 0x1c0000
    s_mov_b32 s27, 0x20000
    buffer_load_dwordx4 v[128:131], v127, s[12:15], s34 offen
    buffer_load_dwordx4 v[132:135], v127, s[12:15], s34 offen offset:1024
    s_mov_b32 s32, 13697024
    buffer_load_dword v152, v2, s[16:19], s32 offen sc1
    s_barrier
    s_cmp_eq_u32 s39, 1
    s_cselect_b32 s52, s50, s48
    s_cselect_b32 s53, s51, s49
    s_and_b32 s53, s53, 65535
    s_mov_b32 s54, 0x1c0000
    s_mov_b32 s55, 0x20000
    v_lshrrev_b32 v2, 4, v1
    v_lshlrev_b32 v2, 3, v2
    v_bfe_u32 v3, v1, 2, 2
    v_add_u32 v2, v2, v3
    v_mul_u32_u24 v120, 240, v2
    v_bfe_u32 v2, v1, 1, 1
    v_mul_u32_u24 v2, 15424, v2
    v_add_u32 v120, v120, v2
    v_and_b32 v2, 1, v1
    v_lshlrev_b32 v2, 3, v2
    v_add_u32 v120, v120, v2
    s_mul_i32 s37, s38, 112
    s_add_u32 s37, s37, 16384
    v_add_u32 v120, s37, v120
    v_and_b32 v2, 15, v1
    v_lshrrev_b32 v3, 1, v2
    v_lshrrev_b32 v4, 4, v1
    v_xor_b32 v3, v3, v4
    v_lshlrev_b32 v3, 4, v3
    v_lshl_add_u32 v121, v2, 7, v3
    s_lshl_b32 s37, s39, 13
    v_add_u32 v121, s37, v121
    v_xor_b32 v122, 64, v121
    v_mov_b32 v8, 0
    v_mov_b32 v9, 0
    v_mov_b32 v10, 0
    v_mov_b32 v11, 0
    v_mov_b32 v12, 0
    v_mov_b32 v13, 0
    v_mov_b32 v14, 0
    v_mov_b32 v15, 0
    v_mov_b32 v16, 0
    v_mov_b32 v17, 0
    v_mov_b32 v18, 0
    v_mov_b32 v19, 0
    v_mov_b32 v20, 0
    v_mov_b32 v21, 0
    v_mov_b32 v22, 0
    v_mov_b32 v23, 0
    v_mov_b32 v24, 0
    v_mov_b32 v25, 0
    v_mov_b32 v26, 0
    v_mov_b32 v27, 0
    v_mov_b32 v28, 0
    v_mov_b32 v29, 0
    v_mov_b32 v30, 0
    v_mov_b32 v31, 0
    v_mov_b32 v32, 0
    v_mov_b32 v33, 0
    v_mov_b32 v34, 0
    v_mov_b32 v35, 0
    v_mov_b32 v36, 0
    v_mov_b32 v37, 0
    v_mov_b32 v38, 0
    v_mov_b32 v39, 0
    v_mov_b32 v40, 0
    v_mov_b32 v41, 0
    v_mov_b32 v42, 0
    v_mov_b32 v43, 0
    v_mov_b32 v44, 0
    v_mov_b32 v45, 0
    v_mov_b32 v46, 0
    v_mov_b32 v47, 0
    v_mov_b32 v48, 0
    v_mov_b32 v49, 0
    v_mov_b32 v50, 0
    v_mov_b32 v51, 0
    v_mov_b32 v52, 0
    v_mov_b32 v53, 0
    v_mov_b32 v54, 0
    v_mov_b32 v55, 0
    v_mov_b32 v56, 0
    v_mov_b32 v57, 0
    v_mov_b32 v58, 0
    v_mov_b32 v59, 0
    v_mov_b32 v60, 0
    v_mov_b32 v61, 0
    v_mov_b32 v62, 0
    v_mov_b32 v63, 0
    v_mov_b32 v64, 0
    v_mov_b32 v65, 0
    v_mov_b32 v66, 0
    v_mov_b32 v67, 0
    v_mov_b32 v68, 0
    v_mov_b32 v69, 0
    v_mov_b32 v70, 0
    v_mov_b32 v71, 0
    v_mov_b32 v72, 0
    v_mov_b32 v73, 0
    v_mov_b32 v74, 0
    v_mov_b32 v75, 0
    v_mov_b32 v76, 0
    v_mov_b32 v77, 0
    v_mov_b32 v78, 0
    v_mov_b32 v79, 0
    v_mov_b32 v80, 0
    v_mov_b32 v81, 0
    v_mov_b32 v82, 0
    v_mov_b32 v83, 0
    v_mov_b32 v84, 0
    v_mov_b32 v85, 0
    v_mov_b32 v86, 0
    v_mov_b32 v87, 0
    v_mov_b32 v88, 0
    v_mov_b32 v89, 0
    v_mov_b32 v90, 0
    v_mov_b32 v91, 0
    v_mov_b32 v92, 0
    v_mov_b32 v93, 0
    v_mov_b32 v94, 0
    v_mov_b32 v95, 0
    v_mov_b32 v96, 0
    v_mov_b32 v97, 0
    v_mov_b32 v98, 0
    v_mov_b32 v99, 0
    v_mov_b32 v100, 0
    v_mov_b32 v101, 0
    v_mov_b32 v102, 0
    v_mov_b32 v103, 0
    v_mov_b32 v104, 0
    v_mov_b32 v105, 0
    v_mov_b32 v106, 0
    v_mov_b32 v107, 0
    v_mov_b32 v108, 0
    v_mov_b32 v109, 0
    v_mov_b32 v110, 0
    v_mov_b32 v111, 0
    v_mov_b32 v112, 0
    v_mov_b32 v113, 0
    v_mov_b32 v114, 0
    v_mov_b32 v115, 0
    v_mov_b32 v116, 0
    v_mov_b32 v117, 0
    v_mov_b32 v118, 0
    v_mov_b32 v119, 0
    s_mov_b32 s40, 0
    s_mov_b32 s41, 47168
    s_mov_b32 s42, 0
    s_waitcnt vmcnt(0)
    v_readfirstlane_b32 s37, v152
    s_nop 0
    s_mul_i32 s37, s37, 0x9E3779B5
    s_add_u32 s37, s37, 0x7F4A7C15
    v_lshlrev_b32 v160, 16, v128
    v_and_b32 v161, s36, v128
    v_lshlrev_b32 v162, 16, v129
    v_and_b32 v163, s36, v129
    v_lshlrev_b32 v164, 16, v130
    v_and_b32 v165, s36, v130
    v_lshlrev_b32 v166, 16, v131
    v_and_b32 v167, s36, v131
    v_lshlrev_b32 v168, 16, v132
    v_and_b32 v169, s36, v132
    v_lshlrev_b32 v170, 16, v133
    v_and_b32 v171, s36, v133
    v_lshlrev_b32 v172, 16, v134
    v_and_b32 v173, s36, v134
    v_lshlrev_b32 v174, 16, v135
    v_and_b32 v175, s36, v135
    v_add_f32 v176, v160, v161
    v_add_f32 v176, v176, v162
    v_add_f32 v176, v176, v163
    v_add_f32 v176, v176, v164
    v_add_f32 v176, v176, v165
    v_add_f32 v176, v176, v166
    v_add_f32 v176, v176, v167
    v_add_f32 v177, v168, v169
    v_add_f32 v177, v177, v170
    v_add_f32 v177, v177, v171
    v_add_f32 v177, v177, v172
    v_add_f32 v177, v177, v173
    v_add_f32 v177, v177, v174
    v_add_f32 v177, v177, v175
    v_add_f32_dpp v176, v176, v176 row_shr:1 row_mask:0xf bank_mask:0xf
    s_nop 0
    v_add_f32_dpp v177, v177, v177 row_shr:1 row_mask:0xf bank_mask:0xf
    s_nop 0
    v_add_f32_dpp v176, v176, v176 row_shr:2 row_mask:0xf bank_mask:0xf
    s_nop 0
    v_add_f32_dpp v177, v177, v177 row_shr:2 row_mask:0xf bank_mask:0xf
    s_nop 0
    v_add_f32_dpp v176, v176, v176 row_shr:4 row_mask:0xf bank_mask:0xf
    s_nop 0
    v_add_f32_dpp v177, v177, v177 row_shr:4 row_mask:0xf bank_mask:0xf
    s_nop 0
    v_add_f32_dpp v176, v176, v176 row_shr:8 row_mask:0xf bank_mask:0xf
    s_nop 0
    v_add_f32_dpp v177, v177, v177 row_shr:8 row_mask:0xf bank_mask:0xf
    s_nop 0
    v_add_f32_dpp v176, v176, v176 row_bcast:15 row_mask:0xa bank_mask:0xf
    s_nop 0
    v_add_f32_dpp v177, v177, v177 row_bcast:15 row_mask:0xa bank_mask:0xf
    s_nop 0
    v_add_f32_dpp v176, v176, v176 row_bcast:31 row_mask:0xc bank_mask:0xf
    s_nop 0
    v_add_f32_dpp v177, v177, v177 row_bcast:31 row_mask:0xc bank_mask:0xf
    v_readlane_b32 s56, v176, 63
    v_readlane_b32 s57, v177, 63
    v_mov_b32 v2, 0x3b000000
    v_mul_f32 v178, s56, v2
    v_mul_f32 v179, s57, v2
    v_sub_f32 v188, v160, v178
    v_sub_f32 v189, v161, v178
    v_sub_f32 v190, v162, v178
    v_sub_f32 v191, v163, v178
    v_sub_f32 v192, v164, v178
    v_sub_f32 v193, v165, v178
    v_sub_f32 v194, v166, v178
    v_sub_f32 v195, v167, v178
    v_sub_f32 v196, v168, v179
    v_sub_f32 v197, v169, v179
    v_sub_f32 v198, v170, v179
    v_sub_f32 v199, v171, v179
    v_sub_f32 v200, v172, v179
    v_sub_f32 v201, v173, v179
    v_sub_f32 v202, v174, v179
    v_sub_f32 v203, v175, v179
    v_mul_f32 v176, v188, v188
    v_fmac_f32 v176, v189, v189
    v_fmac_f32 v176, v190, v190
    v_fmac_f32 v176, v191, v191
    v_fmac_f32 v176, v192, v192
    v_fmac_f32 v176, v193, v193
    v_fmac_f32 v176, v194, v194
    v_fmac_f32 v176, v195, v195
    v_mul_f32 v177, v196, v196
    v_fmac_f32 v177, v197, v197
    v_fmac_f32 v177, v198, v198
    v_fmac_f32 v177, v199, v199
    v_fmac_f32 v177, v200, v200
    v_fmac_f32 v177, v201, v201
    v_fmac_f32 v177, v202, v202
    v_fmac_f32 v177, v203, v203
    v_add_f32_dpp v176, v176, v176 row_shr:1 row_mask:0xf bank_mask:0xf
    s_nop 0
    v_add_f32_dpp v177, v177, v177 row_shr:1 row_mask:0xf bank_mask:0xf
    s_nop 0
    v_add_f32_dpp v176, v176, v176 row_shr:2 row_mask:0xf bank_mask:0xf
    s_nop 0
    v_add_f32_dpp v177, v177, v177 row_shr:2 row_mask:0xf bank_mask:0xf
    s_nop 0
    v_add_f32_dpp v176, v176, v176 row_shr:4 row_mask:0xf bank_mask:0xf
    s_nop 0
    v_add_f32_dpp v177, v177, v177 row_shr:4 row_mask:0xf bank_mask:0xf
    s_nop 0
    v_add_f32_dpp v176, v176, v176 row_shr:8 row_mask:0xf bank_mask:0xf
    s_nop 0
    v_add_f32_dpp v177, v177, v177 row_shr:8 row_mask:0xf bank_mask:0xf
    s_nop 0
    v_add_f32_dpp v176, v176, v176 row_bcast:15 row_mask:0xa bank_mask:0xf
    s_nop 0
    v_add_f32_dpp v177, v177, v177 row_bcast:15 row_mask:0xa bank_mask:0xf
    s_nop 0
    v_add_f32_dpp v176, v176, v176 row_bcast:31 row_mask:0xc bank_mask:0xf
    s_nop 0
    v_add_f32_dpp v177, v177, v177 row_bcast:31 row_mask:0xc bank_mask:0xf
    v_readlane_b32 s56, v176, 63
    v_readlane_b32 s57, v177, 63
    s_nop 0
    v_mul_f32 v180, s56, v2
    s_nop 0
    v_mul_f32 v181, s57, v2
    v_cvt_pk_bf16_f32 v184, v178, v178
    v_lshlrev_b32 v184, 16, v184
    v_cvt_pk_bf16_f32 v186, v179, v179
    v_lshlrev_b32 v186, 16, v186
    v_cvt_pk_bf16_f32 v180, v180, v180
    v_lshlrev_b32 v180, 16, v180
    v_cvt_pk_bf16_f32 v181, v181, v181
    v_lshlrev_b32 v181, 16, v181
    v_add_f32 v180, 0x3727c5ac, v180
    v_add_f32 v181, 0x3727c5ac, v181
    v_cvt_pk_bf16_f32 v180, v180, v180
    v_lshlrev_b32 v180, 16, v180
    v_cvt_pk_bf16_f32 v181, v181, v181
    v_lshlrev_b32 v181, 16, v181
    v_sqrt_f32 v180, v180
    v_sqrt_f32 v181, v181
    v_cvt_pk_bf16_f32 v180, v180, v180
    v_lshlrev_b32 v180, 16, v180
    v_cvt_pk_bf16_f32 v181, v181, v181
    v_lshlrev_b32 v181, 16, v181
    v_rcp_f32 v185, v180
    v_rcp_f32 v187, v181
    v_sub_f32 v160, v160, v184
    v_sub_f32 v161, v161, v184
    v_sub_f32 v162, v162, v184
    v_sub_f32 v163, v163, v184
    v_sub_f32 v164, v164, v184
    v_sub_f32 v165, v165, v184
    v_sub_f32 v166, v166, v184
    v_sub_f32 v167, v167, v184
    v_sub_f32 v168, v168, v186
    v_sub_f32 v169, v169, v186
    v_sub_f32 v170, v170, v186
    v_sub_f32 v171, v171, v186
    v_sub_f32 v172, v172, v186
    v_sub_f32 v173, v173, v186
    v_sub_f32 v174, v174, v186
    v_sub_f32 v175, v175, v186
    v_cvt_pk_bf16_f32 v128, v160, v161
    v_cvt_pk_bf16_f32 v129, v162, v163
    v_cvt_pk_bf16_f32 v130, v164, v165
    v_cvt_pk_bf16_f32 v131, v166, v167
    v_cvt_pk_bf16_f32 v132, v168, v169
    v_cvt_pk_bf16_f32 v133, v170, v171
    v_cvt_pk_bf16_f32 v134, v172, v173
    v_cvt_pk_bf16_f32 v135, v174, v175
    v_lshlrev_b32 v160, 16, v128
    v_and_b32 v161, s36, v128
    v_lshlrev_b32 v162, 16, v129
    v_and_b32 v163, s36, v129
    v_lshlrev_b32 v164, 16, v130
    v_and_b32 v165, s36, v130
    v_lshlrev_b32 v166, 16, v131
    v_and_b32 v167, s36, v131
    v_lshlrev_b32 v168, 16, v132
    v_and_b32 v169, s36, v132
    v_lshlrev_b32 v170, 16, v133
    v_and_b32 v171, s36, v133
    v_lshlrev_b32 v172, 16, v134
    v_and_b32 v173, s36, v134
    v_lshlrev_b32 v174, 16, v135
    v_and_b32 v175, s36, v135
    v_mul_f32 v160, v160, v185
    v_mul_f32 v161, v161, v185
    v_mul_f32 v162, v162, v185
    v_mul_f32 v163, v163, v185
    v_mul_f32 v164, v164, v185
    v_mul_f32 v165, v165, v185
    v_mul_f32 v166, v166, v185
    v_mul_f32 v167, v167, v185
    v_mul_f32 v168, v168, v187
    v_mul_f32 v169, v169, v187
    v_mul_f32 v170, v170, v187
    v_mul_f32 v171, v171, v187
    v_mul_f32 v172, v172, v187
    v_mul_f32 v173, v173, v187
    v_mul_f32 v174, v174, v187
    v_mul_f32 v175, v175, v187
    v_cvt_pk_bf16_f32 v128, v160, v161
    v_cvt_pk_bf16_f32 v129, v162, v163
    v_cvt_pk_bf16_f32 v130, v164, v165
    v_cvt_pk_bf16_f32 v131, v166, v167
    v_cvt_pk_bf16_f32 v132, v168, v169
    v_cvt_pk_bf16_f32 v133, v170, v171
    v_cvt_pk_bf16_f32 v134, v172, v173
    v_cvt_pk_bf16_f32 v135, v174, v175
    s_mul_i32 s32, s3, 2080
    s_add_u32 s32, s32, 131200
    v_add_u32 v2, s32, v127
    ds_write_b128 v2, v[128:131]
    ds_write_b128 v2, v[132:135] offset:1040
    s_lshl_b32 s32, s2, 6
    s_lshl_b32 s33, s3, 4
    s_add_u32 s32, s32, s33
    s_add_u32 s32, s32, 2162688
    v_mov_b32 v2, 0
    s_mov_b64 exec, 1
    buffer_store_dwordx4 v[184:187], v2, s[16:19], s32 offen sc1
    s_mov_b64 exec, -1
    s_waitcnt lgkmcnt(0)
    v_mov_b32 v6, 1
    s_mov_b64 exec, 1
    ds_add_u32 v5, v6 offset:44
    s_mov_b64 exec, -1
    buffer_load_dwordx4 v[136:139], v153, s[52:55], s35 offen
    s_add_u32 s35, s35, 28672
    buffer_load_dwordx4 v[140:143], v153, s[52:55], s35 offen
    s_add_u32 s35, s35, 28672
    buffer_load_dwordx4 v[144:147], v153, s[52:55], s35 offen
    s_add_u32 s35, s35, 28672
    buffer_load_dwordx4 v[148:151], v153, s[52:55], s35 offen
    s_add_u32 m0, s47, 47168
    s_add_u32 s32, s58, 128
    buffer_load_dwordx4 v154, s[12:15], s32 offen lds
    s_add_u32 m0, s47, 51264
    s_add_u32 s32, s58, 32896
    buffer_load_dwordx4 v154, s[12:15], s32 offen lds
    s_add_u32 m0, s47, 55360
    s_add_u32 s32, s58, 65664
    buffer_load_dwordx4 v154, s[12:15], s32 offen lds
    s_add_u32 m0, s47, 59456
    s_add_u32 s32, s58, 98432
    buffer_load_dwordx4 v154, s[12:15], s32 offen lds
    s_add_u32 s33, s59, 229376
    s_add_u32 m0, s47, 63552
    s_nop 0
    buffer_load_dwordx4 v155, s[20:23], s33 offen lds
    s_add_u32 m0, s47, 78976
    s_nop 0
    buffer_load_dwordx4 v155, s[24:27], s33 offen lds
    s_add_u32 m0, s47, 67648
    s_nop 0
    buffer_load_dwordx4 v156, s[20:23], s33 offen lds
    s_add_u32 m0, s47, 83072
    s_nop 0
    buffer_load_dwordx4 v156, s[24:27], s33 offen lds
    s_add_u32 m0, s47, 71744
    s_nop 0
    buffer_load_dwordx4 v157, s[20:23], s33 offen lds
    s_add_u32 m0, s47, 87168
    s_nop 0
    buffer_load_dwordx4 v157, s[24:27], s33 offen lds
    s_mov_b64 exec, s[60:61]
    s_add_u32 m0, s47, 75840
    s_nop 0
    buffer_load_dwordx4 v158, s[20:23], s33 offen lds
    s_add_u32 m0, s47, 91264
    s_nop 0
    buffer_load_dwordx4 v158, s[24:27], s33 offen lds
    s_mov_b64 exec, -1
    s_mov_b32 s20, s8
    s_and_b32 s21, s9, 65535
    s_mov_b32 s22, 0x1c0000
    s_mov_b32 s23, 0x20000
    s_mov_b32 s24, s10
    s_and_b32 s25, s11, 65535
    s_mov_b32 s26, 0x200000
    s_mov_b32 s27, 0x20000
    s_waitcnt vmcnt(12)
    v_lshlrev_b32 v160, 16, v136
    v_and_b32 v161, s36, v136
    v_lshlrev_b32 v162, 16, v137
    v_and_b32 v163, s36, v137
    v_lshlrev_b32 v164, 16, v138
    v_and_b32 v165, s36, v138
    v_lshlrev_b32 v166, 16, v139
    v_and_b32 v167, s36, v139
    v_lshlrev_b32 v3, 16, v140
    v_and_b32 v4, s36, v140
    v_add_f32 v160, v160, v3
    v_add_f32 v161, v161, v4
    v_lshlrev_b32 v3, 16, v141
    v_and_b32 v4, s36, v141
    v_add_f32 v162, v162, v3
    v_add_f32 v163, v163, v4
    v_lshlrev_b32 v3, 16, v142
    v_and_b32 v4, s36, v142
    v_add_f32 v164, v164, v3
    v_add_f32 v165, v165, v4
    v_lshlrev_b32 v3, 16, v143
    v_and_b32 v4, s36, v143
    v_add_f32 v166, v166, v3
    v_add_f32 v167, v167, v4
    v_lshlrev_b32 v3, 16, v144
    v_and_b32 v4, s36, v144
    v_add_f32 v160, v160, v3
    v_add_f32 v161, v161, v4
    v_lshlrev_b32 v3, 16, v145
    v_and_b32 v4, s36, v145
    v_add_f32 v162, v162, v3
    v_add_f32 v163, v163, v4
    v_lshlrev_b32 v3, 16, v146
    v_and_b32 v4, s36, v146
    v_add_f32 v164, v164, v3
    v_add_f32 v165, v165, v4
    v_lshlrev_b32 v3, 16, v147
    v_and_b32 v4, s36, v147
    v_add_f32 v166, v166, v3
    v_add_f32 v167, v167, v4
    v_lshlrev_b32 v3, 16, v148
    v_and_b32 v4, s36, v148
    v_add_f32 v160, v160, v3
    v_add_f32 v161, v161, v4
    v_lshlrev_b32 v3, 16, v149
    v_and_b32 v4, s36, v149
    v_add_f32 v162, v162, v3
    v_add_f32 v163, v163, v4
    v_lshlrev_b32 v3, 16, v150
    v_and_b32 v4, s36, v150
    v_add_f32 v164, v164, v3
    v_add_f32 v165, v165, v4
    v_lshlrev_b32 v3, 16, v151
    v_and_b32 v4, s36, v151
    v_add_f32 v166, v166, v3
    v_add_f32 v167, v167, v4
GS_1:
    ds_read_b32 v6, v5 offset:44
    s_waitcnt lgkmcnt(0)
    v_readfirstlane_b32 s46, v6
    s_nop 0
    s_cmp_lt_u32 s46, 4
    s_cbranch_scc1 GS_1
    v_bfe_u32 v2, v1, 2, 2
    v_mul_u32_u24 v2, 1040, v2
    v_lshrrev_b32 v3, 4, v1
    v_lshlrev_b32 v3, 5, v3
    v_add_u32 v2, v2, v3
    v_and_b32 v3, 3, v1
    v_lshl_add_u32 v2, v3, 3, v2
    s_lshl_b32 s32, s3, 8
    s_add_u32 s32, s32, 131200
    v_add_u32 v2, s32, v2
    ds_read_b64_tr_b16 v[128:129], v2 offset:0
    ds_read_b64_tr_b16 v[130:131], v2 offset:4160
    ds_read_b64_tr_b16 v[132:133], v2 offset:128
    ds_read_b64_tr_b16 v[134:135], v2 offset:4288
    v_add_f32_dpp v160, v160, v160 row_ror:8 row_mask:0xf bank_mask:0xf
    v_add_f32_dpp v161, v161, v161 row_ror:8 row_mask:0xf bank_mask:0xf
    v_add_f32_dpp v162, v162, v162 row_ror:8 row_mask:0xf bank_mask:0xf
    v_add_f32_dpp v163, v163, v163 row_ror:8 row_mask:0xf bank_mask:0xf
    v_add_f32_dpp v164, v164, v164 row_ror:8 row_mask:0xf bank_mask:0xf
    v_add_f32_dpp v165, v165, v165 row_ror:8 row_mask:0xf bank_mask:0xf
    v_add_f32_dpp v166, v166, v166 row_ror:8 row_mask:0xf bank_mask:0xf
    v_add_f32_dpp v167, v167, v167 row_ror:8 row_mask:0xf bank_mask:0xf
    v_mov_b32 v188, v160
    v_mov_b32 v189, v161
    v_mov_b32 v190, v162
    v_mov_b32 v191, v163
    v_mov_b32 v192, v164
    v_mov_b32 v193, v165
    v_mov_b32 v194, v166
    v_mov_b32 v195, v167
    s_waitcnt lgkmcnt(0)
    s_lshl_b32 s32, s2, 13
    s_lshl_b32 s33, s3, 11
    s_add_u32 s32, s32, s33
    s_add_u32 s32, s32, 4096
    buffer_store_dwordx4 v[128:131], v127, s[16:19], s32 offen sc1
    buffer_store_dwordx4 v[132:135], v127, s[16:19], s32 offen offset:1024 sc1
    v_permlane16_swap_b32 v160, v188
    v_permlane16_swap_b32 v161, v189
    v_permlane16_swap_b32 v162, v190
    v_permlane16_swap_b32 v163, v191
    v_permlane16_swap_b32 v164, v192
    v_permlane16_swap_b32 v165, v193
    v_permlane16_swap_b32 v166, v194
    v_permlane16_swap_b32 v167, v195
    v_add_f32 v160, v160, v188
    v_add_f32 v161, v161, v189
    v_add_f32 v162, v162, v190
    v_add_f32 v163, v163, v191
    v_add_f32 v164, v164, v192
    v_add_f32 v165, v165, v193
    v_add_f32 v166, v166, v194
    v_add_f32 v167, v167, v195
    v_mov_b32 v188, v160
    v_mov_b32 v189, v161
    v_mov_b32 v190, v162
    v_mov_b32 v191, v163
    v_mov_b32 v192, v164
    v_mov_b32 v193, v165
    v_mov_b32 v194, v166
    v_mov_b32 v195, v167
    v_permlane32_swap_b32 v160, v188
    v_permlane32_swap_b32 v161, v189
    v_permlane32_swap_b32 v162, v190
    v_permlane32_swap_b32 v163, v191
    v_permlane32_swap_b32 v164, v192
    v_permlane32_swap_b32 v165, v193
    v_permlane32_swap_b32 v166, v194
    v_permlane32_swap_b32 v167, v195
    v_add_f32 v160, v160, v188
    v_add_f32 v161, v161, v189
    v_add_f32 v162, v162, v190
    v_add_f32 v163, v163, v191
    v_add_f32 v164, v164, v192
    v_add_f32 v165, v165, v193
    v_add_f32 v166, v166, v194
    v_add_f32 v167, v167, v195
    s_lshl_b32 s32, s29, 4
    s_add_u32 s32, s32, s28
    s_mul_i32 s32, s32, 896
    s_mul_i32 s33, s3, 224
    s_add_u32 s32, s32, s33
    s_add_u32 s32, s32, 2228224
    v_lshlrev_b32 v2, 5, v1
    s_mov_b64 exec, 0x7f
    buffer_store_dwordx4 v[160:163], v2, s[16:19], s32 offen sc1
    buffer_store_dwordx4 v[164:167], v2, s[16:19], s32 offen offset:16 sc1
    s_mov_b64 exec, -1
    s_nop 1
    s_barrier
    s_setprio 2
    ds_read_b128 v[184:187], v121 offset:0
    ds_read_b128 v[188:191], v121 offset:2048
    ds_read_b128 v[192:195], v121 offset:4096
    ds_read_b128 v[196:199], v121 offset:6144
    ds_read_b64_tr_b16 v[128:129], v120 offset:0
    ds_read_b64_tr_b16 v[130:131], v120 offset:960
    ds_read_b64_tr_b16 v[132:133], v120 offset:16
    ds_read_b64_tr_b16 v[134:135], v120 offset:976
    ds_read_b64_tr_b16 v[136:137], v120 offset:32
    ds_read_b64_tr_b16 v[138:139], v120 offset:992
    ds_read_b64_tr_b16 v[140:141], v120 offset:48
    ds_read_b64_tr_b16 v[142:143], v120 offset:1008
    ds_read_b64_tr_b16 v[144:145], v120 offset:64
    ds_read_b64_tr_b16 v[146:147], v120 offset:1024
    ds_read_b64_tr_b16 v[148:149], v120 offset:80
    ds_read_b64_tr_b16 v[150:151], v120 offset:1040
    ds_read_b64_tr_b16 v[152:153], v120 offset:96
    ds_read_b64_tr_b16 v[154:155], v120 offset:1056
F_LOOP:
    v_add_u32 v123, s40, v120
    v_add_u32 v124, s40, v122
    v_add_u32 v125, s41, v120
    v_add_u32 v126, s41, v121
    s_waitcnt lgkmcnt(0)
    v_mfma_f32_16x16x32_bf16 v[8:11], v[128:131], v[184:187], v[8:11]
    ds_read_b128 v[200:203], v124 offset:0
    v_mfma_f32_16x16x32_bf16 v[12:15], v[128:131], v[188:191], v[12:15]
    ds_read_b128 v[204:207], v124 offset:2048
    v_mfma_f32_16x16x32_bf16 v[16:19], v[128:131], v[192:195], v[16:19]
    ds_read_b128 v[208:211], v124 offset:4096
    v_mfma_f32_16x16x32_bf16 v[20:23], v[128:131], v[196:199], v[20:23]
    ds_read_b128 v[212:215], v124 offset:6144
    v_mfma_f32_16x16x32_bf16 v[24:27], v[132:135], v[184:187], v[24:27]
    ds_read_b64_tr_b16 v[156:157], v123 offset:7680
    v_mfma_f32_16x16x32_bf16 v[28:31], v[132:135], v[188:191], v[28:31]
    ds_read_b64_tr_b16 v[158:159], v123 offset:8640
    v_mfma_f32_16x16x32_bf16 v[32:35], v[132:135], v[192:195], v[32:35]
    ds_read_b64_tr_b16 v[160:161], v123 offset:7696
    v_mfma_f32_16x16x32_bf16 v[36:39], v[132:135], v[196:199], v[36:39]
    ds_read_b64_tr_b16 v[162:163], v123 offset:8656
    v_mfma_f32_16x16x32_bf16 v[40:43], v[136:139], v[184:187], v[40:43]
    ds_read_b64_tr_b16 v[164:165], v123 offset:7712
    v_mfma_f32_16x16x32_bf16 v[44:47], v[136:139], v[188:191], v[44:47]
    ds_read_b64_tr_b16 v[166:167], v123 offset:8672
    v_mfma_f32_16x16x32_bf16 v[48:51], v[136:139], v[192:195], v[48:51]
    ds_read_b64_tr_b16 v[168:169], v123 offset:7728
    v_mfma_f32_16x16x32_bf16 v[52:55], v[136:139], v[196:199], v[52:55]
    ds_read_b64_tr_b16 v[170:171], v123 offset:8688
    v_mfma_f32_16x16x32_bf16 v[56:59], v[140:143], v[184:187], v[56:59]
    ds_read_b64_tr_b16 v[172:173], v123 offset:7744
    v_mfma_f32_16x16x32_bf16 v[60:63], v[140:143], v[188:191], v[60:63]
    ds_read_b64_tr_b16 v[174:175], v123 offset:8704
    v_mfma_f32_16x16x32_bf16 v[64:67], v[140:143], v[192:195], v[64:67]
    ds_read_b64_tr_b16 v[176:177], v123 offset:7760
    v_mfma_f32_16x16x32_bf16 v[68:71], v[140:143], v[196:199], v[68:71]
    ds_read_b64_tr_b16 v[178:179], v123 offset:8720
    v_mfma_f32_16x16x32_bf16 v[72:75], v[144:147], v[184:187], v[72:75]
    ds_read_b64_tr_b16 v[180:181], v123 offset:7776
    v_mfma_f32_16x16x32_bf16 v[76:79], v[144:147], v[188:191], v[76:79]
    ds_read_b64_tr_b16 v[182:183], v123 offset:8736
    v_mfma_f32_16x16x32_bf16 v[80:83], v[144:147], v[192:195], v[80:83]
    v_mfma_f32_16x16x32_bf16 v[84:87], v[144:147], v[196:199], v[84:87]
    v_mfma_f32_16x16x32_bf16 v[88:91], v[148:151], v[184:187], v[88:91]
    v_mfma_f32_16x16x32_bf16 v[92:95], v[148:151], v[188:191], v[92:95]
    v_mfma_f32_16x16x32_bf16 v[96:99], v[148:151], v[192:195], v[96:99]
    v_mfma_f32_16x16x32_bf16 v[100:103], v[148:151], v[196:199], v[100:103]
    v_mfma_f32_16x16x32_bf16 v[104:107], v[152:155], v[184:187], v[104:107]
    v_mfma_f32_16x16x32_bf16 v[108:111], v[152:155], v[188:191], v[108:111]
    v_mfma_f32_16x16x32_bf16 v[112:115], v[152:155], v[192:195], v[112:115]
    v_mfma_f32_16x16x32_bf16 v[116:119], v[152:155], v[196:199], v[116:119]
    s_waitcnt vmcnt(4) lgkmcnt(0)
    s_barrier
    s_cmp_eq_u32 s42, 1
    s_cbranch_scc0 F_NOA
    s_waitcnt vmcnt(0)
    v_mov_b32 v216, 1
    s_mov_b64 exec, 1
    ds_add_rtn_u32 v217, v5, v216 offset:48
    s_waitcnt lgkmcnt(0)
    v_readfirstlane_b32 s32, v217
    s_mov_b64 exec, -1
    s_cmp_eq_u32 s32, 3
    s_cbranch_scc0 F_NOA
    s_lshl_b32 s32, s2, 2
    s_add_u32 s32, s32, 13729792
    v_lshlrev_b32 v216, 10, v1
    v_mov_b32 v217, s37
    s_mov_b64 exec, 0xff
    buffer_store_dword v217, v216, s[16:19], s32 offen sc1
    s_mov_b64 exec, -1
F_NOA:
    v_mfma_f32_16x16x32_bf16 v[8:11], v[156:159], v[200:203], v[8:11]
    ds_read_b128 v[184:187], v126 offset:0
    v_mfma_f32_16x16x32_bf16 v[12:15], v[156:159], v[204:207], v[12:15]
    ds_read_b128 v[188:191], v126 offset:2048
    v_mfma_f32_16x16x32_bf16 v[16:19], v[156:159], v[208:211], v[16:19]
    ds_read_b128 v[192:195], v126 offset:4096
    v_mfma_f32_16x16x32_bf16 v[20:23], v[156:159], v[212:215], v[20:23]
    ds_read_b128 v[196:199], v126 offset:6144
    v_mfma_f32_16x16x32_bf16 v[24:27], v[160:163], v[200:203], v[24:27]
    ds_read_b64_tr_b16 v[128:129], v125 offset:0
    v_mfma_f32_16x16x32_bf16 v[28:31], v[160:163], v[204:207], v[28:31]
    ds_read_b64_tr_b16 v[130:131], v125 offset:960
    v_mfma_f32_16x16x32_bf16 v[32:35], v[160:163], v[208:211], v[32:35]
    ds_read_b64_tr_b16 v[132:133], v125 offset:16
    v_mfma_f32_16x16x32_bf16 v[36:39], v[160:163], v[212:215], v[36:39]
    ds_read_b64_tr_b16 v[134:135], v125 offset:976
    v_mfma_f32_16x16x32_bf16 v[40:43], v[164:167], v[200:203], v[40:43]
    ds_read_b64_tr_b16 v[136:137], v125 offset:32
    v_mfma_f32_16x16x32_bf16 v[44:47], v[164:167], v[204:207], v[44:47]
    ds_read_b64_tr_b16 v[138:139], v125 offset:992
    v_mfma_f32_16x16x32_bf16 v[48:51], v[164:167], v[208:211], v[48:51]
    ds_read_b64_tr_b16 v[140:141], v125 offset:48
    v_mfma_f32_16x16x32_bf16 v[52:55], v[164:167], v[212:215], v[52:55]
    ds_read_b64_tr_b16 v[142:143], v125 offset:1008
    v_mfma_f32_16x16x32_bf16 v[56:59], v[168:171], v[200:203], v[56:59]
    ds_read_b64_tr_b16 v[144:145], v125 offset:64
    v_mfma_f32_16x16x32_bf16 v[60:63], v[168:171], v[204:207], v[60:63]
    ds_read_b64_tr_b16 v[146:147], v125 offset:1024
    v_mfma_f32_16x16x32_bf16 v[64:67], v[168:171], v[208:211], v[64:67]
    ds_read_b64_tr_b16 v[148:149], v125 offset:80
    v_mfma_f32_16x16x32_bf16 v[68:71], v[168:171], v[212:215], v[68:71]
    ds_read_b64_tr_b16 v[150:151], v125 offset:1040
    v_mfma_f32_16x16x32_bf16 v[72:75], v[172:175], v[200:203], v[72:75]
    ds_read_b64_tr_b16 v[152:153], v125 offset:96
    v_mfma_f32_16x16x32_bf16 v[76:79], v[172:175], v[204:207], v[76:79]
    ds_read_b64_tr_b16 v[154:155], v125 offset:1056
    v_mfma_f32_16x16x32_bf16 v[80:83], v[172:175], v[208:211], v[80:83]
    v_mfma_f32_16x16x32_bf16 v[84:87], v[172:175], v[212:215], v[84:87]
    v_mfma_f32_16x16x32_bf16 v[88:91], v[176:179], v[200:203], v[88:91]
    v_mfma_f32_16x16x32_bf16 v[92:95], v[176:179], v[204:207], v[92:95]
    v_mfma_f32_16x16x32_bf16 v[96:99], v[176:179], v[208:211], v[96:99]
    v_mfma_f32_16x16x32_bf16 v[100:103], v[176:179], v[212:215], v[100:103]
    v_mfma_f32_16x16x32_bf16 v[104:107], v[180:183], v[200:203], v[104:107]
    v_mfma_f32_16x16x32_bf16 v[108:111], v[180:183], v[204:207], v[108:111]
    v_mfma_f32_16x16x32_bf16 v[112:115], v[180:183], v[208:211], v[112:115]
    v_mfma_f32_16x16x32_bf16 v[116:119], v[180:183], v[212:215], v[116:119]
    s_mov_b32 s40, s41
    s_add_u32 s41, s41, 47168
    s_cmp_eq_u32 s41, 141504
    s_cselect_b32 s41, 0, s41
    s_add_u32 s42, s42, 1
    s_cmp_lt_u32 s42, 8
    s_cbranch_scc1 F_LOOP
    s_waitcnt lgkmcnt(0)
    s_mul_i32 s43, s38, 20480
    s_cmp_eq_u32 s39, 0
    s_cselect_b32 s32, 94336, 0
    s_add_u32 s43, s43, s32
    v_lshrrev_b32 v2, 4, v1
    v_lshlrev_b32 v2, 1, v2
    v_and_b32 v2, 6, v2
    v_and_b32 v3, 7, v1
    v_xor_b32 v2, v2, v3
    v_lshlrev_b32 v2, 4, v2
    v_lshrrev_b32 v3, 3, v1
    v_lshl_add_u32 v120, v3, 10, v2
    s_mul_i32 s32, s3, 458752
    s_lshl_b32 s33, s31, 7
    s_add_u32 s45, s32, s33
    v_bfe_u32 v2, v1, 4, 1
    v_lshlrev_b32 v2, 4, v2
    s_mul_i32 s32, s38, 224
    s_add_u32 s32, s32, 162816
    v_add_u32 v2, s32, v2
    ds_read_b128 v[124:127], v2 offset:0
    ds_read_b128 v[128:131], v2 offset:32
    ds_read_b128 v[132:135], v2 offset:64
    ds_read_b128 v[136:139], v2 offset:96
    ds_read_b128 v[140:143], v2 offset:128
    ds_read_b128 v[144:147], v2 offset:160
    ds_read_b128 v[148:151], v2 offset:192
    ds_read_b128 v[152:155], v2 offset:448
    ds_read_b128 v[156:159], v2 offset:480
    ds_read_b128 v[160:163], v2 offset:512
    ds_read_b128 v[164:167], v2 offset:544
    ds_read_b128 v[168:171], v2 offset:576
    ds_read_b128 v[172:175], v2 offset:608
    ds_read_b128 v[176:179], v2 offset:640
    v_lshrrev_b32 v3, 5, v1
    v_lshlrev_b32 v3, 4, v3
    v_and_b32 v4, 15, v1
    v_add_u32 v3, v3, v4
    v_lshlrev_b32 v3, 3, v3
    s_lshl_b32 s32, s39, 9
    s_add_u32 s32, s32, 161792
    v_add_u32 v3, s32, v3
    ds_read_b64 v[180:181], v3
    ds_read_b64 v[182:183], v3 offset:256
    v_mov_b32 v122, 1.0
    v_mov_b32 v123, 1.0
    v_lshrrev_b32 v2, 5, v1
    s_mov_b32 s32, 57472
    v_mul_lo_u32 v121, v2, s32
    v_bfe_u32 v2, v1, 4, 1
    v_lshl_add_u32 v121, v2, 8, v121
    v_lshl_add_u32 v121, v4, 4, v121
    s_lshl_b32 s32, s28, 3
    s_lshl_b32 s33, s39, 2
    s_add_u32 s32, s32, s33
    s_mul_i32 s32, s32, 57472
    s_mul_i32 s33, s29, 3584
    s_add_u32 s32, s32, s33
    s_add_u32 s34, s32, 3145728
    s_add_u32 s35, s34, 114944
    s_waitcnt lgkmcnt(0)
    v_mul_f32 v184, 0xbfb8aa3b, v181
    v_mul_f32 v186, 0xbfb8aa3b, v183
    v_permlane32_swap_b32 v8, v12
    v_permlane32_swap_b32 v9, v13
    v_permlane32_swap_b32 v10, v14
    v_permlane32_swap_b32 v11, v15
    v_permlane32_swap_b32 v24, v28
    v_permlane32_swap_b32 v25, v29
    v_permlane32_swap_b32 v26, v30
    v_permlane32_swap_b32 v27, v31
    v_pk_fma_f32 v[8:9], v[124:125], v[180:181], v[8:9] op_sel_hi:[1,0,1] neg_lo:[0,1,0] neg_hi:[0,1,0]
    v_pk_fma_f32 v[12:13], v[152:153], v[180:181], v[12:13] op_sel_hi:[1,0,1] neg_lo:[0,1,0] neg_hi:[0,1,0]
    v_pk_fma_f32 v[10:11], v[126:127], v[180:181], v[10:11] op_sel_hi:[1,0,1] neg_lo:[0,1,0] neg_hi:[0,1,0]
    v_pk_fma_f32 v[14:15], v[154:155], v[180:181], v[14:15] op_sel_hi:[1,0,1] neg_lo:[0,1,0] neg_hi:[0,1,0]
    v_pk_fma_f32 v[24:25], v[128:129], v[180:181], v[24:25] op_sel_hi:[1,0,1] neg_lo:[0,1,0] neg_hi:[0,1,0]
    v_pk_fma_f32 v[28:29], v[156:157], v[180:181], v[28:29] op_sel_hi:[1,0,1] neg_lo:[0,1,0] neg_hi:[0,1,0]
    v_pk_fma_f32 v[26:27], v[130:131], v[180:181], v[26:27] op_sel_hi:[1,0,1] neg_lo:[0,1,0] neg_hi:[0,1,0]
    v_pk_fma_f32 v[30:31], v[158:159], v[180:181], v[30:31] op_sel_hi:[1,0,1] neg_lo:[0,1,0] neg_hi:[0,1,0]
    v_pk_mul_f32 v[206:207], v[8:9], v[184:185] op_sel_hi:[1,0]
    v_pk_mul_f32 v[208:209], v[10:11], v[184:185] op_sel_hi:[1,0]
    v_pk_mul_f32 v[214:215], v[24:25], v[184:185] op_sel_hi:[1,0]
    v_pk_mul_f32 v[216:217], v[26:27], v[184:185] op_sel_hi:[1,0]
    v_exp_f32 v206, v206
    v_exp_f32 v207, v207
    v_exp_f32 v208, v208
    v_exp_f32 v209, v209
    v_exp_f32 v214, v214
    v_exp_f32 v215, v215
    v_exp_f32 v216, v216
    v_exp_f32 v217, v217
    v_pk_mul_f32 v[210:211], v[8:9], v[12:13]
    v_pk_mul_f32 v[212:213], v[10:11], v[14:15]
    v_pk_mul_f32 v[218:219], v[24:25], v[28:29]
    v_pk_mul_f32 v[220:221], v[26:27], v[30:31]
    v_pk_add_f32 v[206:207], v[206:207], v[122:123]
    v_pk_add_f32 v[208:209], v[208:209], v[122:123]
    v_pk_add_f32 v[214:215], v[214:215], v[122:123]
    v_pk_add_f32 v[216:217], v[216:217], v[122:123]
    v_rcp_f32 v206, v206
    v_rcp_f32 v207, v207
    v_rcp_f32 v208, v208
    v_rcp_f32 v209, v209
    v_rcp_f32 v214, v214
    v_rcp_f32 v215, v215
    v_rcp_f32 v216, v216
    v_rcp_f32 v217, v217
    v_pk_mul_f32 v[210:211], v[210:211], v[206:207]
    v_pk_mul_f32 v[212:213], v[212:213], v[208:209]
    v_pk_mul_f32 v[218:219], v[218:219], v[214:215]
    v_pk_mul_f32 v[220:221], v[220:221], v[216:217]
    v_cvt_pk_bf16_f32 v190, v210, v211
    v_cvt_pk_bf16_f32 v191, v212, v213
    v_cvt_pk_bf16_f32 v192, v218, v219
    v_cvt_pk_bf16_f32 v193, v220, v221
    v_permlane32_swap_b32 v40, v44
    v_permlane32_swap_b32 v41, v45
    v_permlane32_swap_b32 v42, v46
    v_permlane32_swap_b32 v43, v47
    v_permlane32_swap_b32 v56, v60
    v_permlane32_swap_b32 v57, v61
    v_permlane32_swap_b32 v58, v62
    v_permlane32_swap_b32 v59, v63
    v_pk_fma_f32 v[40:41], v[132:133], v[180:181], v[40:41] op_sel_hi:[1,0,1] neg_lo:[0,1,0] neg_hi:[0,1,0]
    v_pk_fma_f32 v[44:45], v[160:161], v[180:181], v[44:45] op_sel_hi:[1,0,1] neg_lo:[0,1,0] neg_hi:[0,1,0]
    v_pk_fma_f32 v[42:43], v[134:135], v[180:181], v[42:43] op_sel_hi:[1,0,1] neg_lo:[0,1,0] neg_hi:[0,1,0]
    v_pk_fma_f32 v[46:47], v[162:163], v[180:181], v[46:47] op_sel_hi:[1,0,1] neg_lo:[0,1,0] neg_hi:[0,1,0]
    v_pk_fma_f32 v[56:57], v[136:137], v[180:181], v[56:57] op_sel_hi:[1,0,1] neg_lo:[0,1,0] neg_hi:[0,1,0]
    v_pk_fma_f32 v[60:61], v[164:165], v[180:181], v[60:61] op_sel_hi:[1,0,1] neg_lo:[0,1,0] neg_hi:[0,1,0]
    v_pk_fma_f32 v[58:59], v[138:139], v[180:181], v[58:59] op_sel_hi:[1,0,1] neg_lo:[0,1,0] neg_hi:[0,1,0]
    v_pk_fma_f32 v[62:63], v[166:167], v[180:181], v[62:63] op_sel_hi:[1,0,1] neg_lo:[0,1,0] neg_hi:[0,1,0]
    v_pk_mul_f32 v[206:207], v[40:41], v[184:185] op_sel_hi:[1,0]
    v_pk_mul_f32 v[208:209], v[42:43], v[184:185] op_sel_hi:[1,0]
    v_pk_mul_f32 v[214:215], v[56:57], v[184:185] op_sel_hi:[1,0]
    v_pk_mul_f32 v[216:217], v[58:59], v[184:185] op_sel_hi:[1,0]
    v_exp_f32 v206, v206
    v_exp_f32 v207, v207
    v_exp_f32 v208, v208
    v_exp_f32 v209, v209
    v_exp_f32 v214, v214
    v_exp_f32 v215, v215
    v_exp_f32 v216, v216
    v_exp_f32 v217, v217
    v_pk_mul_f32 v[210:211], v[40:41], v[44:45]
    v_pk_mul_f32 v[212:213], v[42:43], v[46:47]
    v_pk_mul_f32 v[218:219], v[56:57], v[60:61]
    v_pk_mul_f32 v[220:221], v[58:59], v[62:63]
    v_pk_add_f32 v[206:207], v[206:207], v[122:123]
    v_pk_add_f32 v[208:209], v[208:209], v[122:123]
    v_pk_add_f32 v[214:215], v[214:215], v[122:123]
    v_pk_add_f32 v[216:217], v[216:217], v[122:123]
    v_rcp_f32 v206, v206
    v_rcp_f32 v207, v207
    v_rcp_f32 v208, v208
    v_rcp_f32 v209, v209
    v_rcp_f32 v214, v214
    v_rcp_f32 v215, v215
    v_rcp_f32 v216, v216
    v_rcp_f32 v217, v217
    v_pk_mul_f32 v[210:211], v[210:211], v[206:207]
    v_pk_mul_f32 v[212:213], v[212:213], v[208:209]
    v_pk_mul_f32 v[218:219], v[218:219], v[214:215]
    v_pk_mul_f32 v[220:221], v[220:221], v[216:217]
    v_cvt_pk_bf16_f32 v194, v210, v211
    v_cvt_pk_bf16_f32 v195, v212, v213
    v_cvt_pk_bf16_f32 v196, v218, v219
    v_cvt_pk_bf16_f32 v197, v220, v221
    v_permlane32_swap_b32 v72, v76
    v_permlane32_swap_b32 v73, v77
    v_permlane32_swap_b32 v74, v78
    v_permlane32_swap_b32 v75, v79
    v_permlane32_swap_b32 v88, v92
    v_permlane32_swap_b32 v89, v93
    v_permlane32_swap_b32 v90, v94
    v_permlane32_swap_b32 v91, v95
    v_pk_fma_f32 v[72:73], v[140:141], v[180:181], v[72:73] op_sel_hi:[1,0,1] neg_lo:[0,1,0] neg_hi:[0,1,0]
    v_pk_fma_f32 v[76:77], v[168:169], v[180:181], v[76:77] op_sel_hi:[1,0,1] neg_lo:[0,1,0] neg_hi:[0,1,0]
    v_pk_fma_f32 v[74:75], v[142:143], v[180:181], v[74:75] op_sel_hi:[1,0,1] neg_lo:[0,1,0] neg_hi:[0,1,0]
    v_pk_fma_f32 v[78:79], v[170:171], v[180:181], v[78:79] op_sel_hi:[1,0,1] neg_lo:[0,1,0] neg_hi:[0,1,0]
    v_pk_fma_f32 v[88:89], v[144:145], v[180:181], v[88:89] op_sel_hi:[1,0,1] neg_lo:[0,1,0] neg_hi:[0,1,0]
    v_pk_fma_f32 v[92:93], v[172:173], v[180:181], v[92:93] op_sel_hi:[1,0,1] neg_lo:[0,1,0] neg_hi:[0,1,0]
    v_pk_fma_f32 v[90:91], v[146:147], v[180:181], v[90:91] op_sel_hi:[1,0,1] neg_lo:[0,1,0] neg_hi:[0,1,0]
    v_pk_fma_f32 v[94:95], v[174:175], v[180:181], v[94:95] op_sel_hi:[1,0,1] neg_lo:[0,1,0] neg_hi:[0,1,0]
    v_pk_mul_f32 v[206:207], v[72:73], v[184:185] op_sel_hi:[1,0]
    v_pk_mul_f32 v[208:209], v[74:75], v[184:185] op_sel_hi:[1,0]
    v_pk_mul_f32 v[214:215], v[88:89], v[184:185] op_sel_hi:[1,0]
    v_pk_mul_f32 v[216:217], v[90:91], v[184:185] op_sel_hi:[1,0]
    v_exp_f32 v206, v206
    v_exp_f32 v207, v207
    v_exp_f32 v208, v208
    v_exp_f32 v209, v209
    v_exp_f32 v214, v214
    v_exp_f32 v215, v215
    v_exp_f32 v216, v216
    v_exp_f32 v217, v217
    v_pk_mul_f32 v[210:211], v[72:73], v[76:77]
    v_pk_mul_f32 v[212:213], v[74:75], v[78:79]
    v_pk_mul_f32 v[218:219], v[88:89], v[92:93]
    v_pk_mul_f32 v[220:221], v[90:91], v[94:95]
    v_pk_add_f32 v[206:207], v[206:207], v[122:123]
    v_pk_add_f32 v[208:209], v[208:209], v[122:123]
    v_pk_add_f32 v[214:215], v[214:215], v[122:123]
    v_pk_add_f32 v[216:217], v[216:217], v[122:123]
    v_rcp_f32 v206, v206
    v_rcp_f32 v207, v207
    v_rcp_f32 v208, v208
    v_rcp_f32 v209, v209
    v_rcp_f32 v214, v214
    v_rcp_f32 v215, v215
    v_rcp_f32 v216, v216
    v_rcp_f32 v217, v217
    v_pk_mul_f32 v[210:211], v[210:211], v[206:207]
    v_pk_mul_f32 v[212:213], v[212:213], v[208:209]
    v_pk_mul_f32 v[218:219], v[218:219], v[214:215]
    v_pk_mul_f32 v[220:221], v[220:221], v[216:217]
    v_cvt_pk_bf16_f32 v198, v210, v211
    v_cvt_pk_bf16_f32 v199, v212, v213
    v_cvt_pk_bf16_f32 v200, v218, v219
    v_cvt_pk_bf16_f32 v201, v220, v221
    v_permlane32_swap_b32 v104, v108
    v_permlane32_swap_b32 v105, v109
    v_permlane32_swap_b32 v106, v110
    v_permlane32_swap_b32 v107, v111
    v_pk_fma_f32 v[104:105], v[148:149], v[180:181], v[104:105] op_sel_hi:[1,0,1] neg_lo:[0,1,0] neg_hi:[0,1,0]
    v_pk_fma_f32 v[108:109], v[176:177], v[180:181], v[108:109] op_sel_hi:[1,0,1] neg_lo:[0,1,0] neg_hi:[0,1,0]
    v_pk_fma_f32 v[106:107], v[150:151], v[180:181], v[106:107] op_sel_hi:[1,0,1] neg_lo:[0,1,0] neg_hi:[0,1,0]
    v_pk_fma_f32 v[110:111], v[178:179], v[180:181], v[110:111] op_sel_hi:[1,0,1] neg_lo:[0,1,0] neg_hi:[0,1,0]
    v_pk_mul_f32 v[206:207], v[104:105], v[184:185] op_sel_hi:[1,0]
    v_pk_mul_f32 v[208:209], v[106:107], v[184:185] op_sel_hi:[1,0]
    v_exp_f32 v206, v206
    v_exp_f32 v207, v207
    v_exp_f32 v208, v208
    v_exp_f32 v209, v209
    v_pk_mul_f32 v[210:211], v[104:105], v[108:109]
    v_pk_mul_f32 v[212:213], v[106:107], v[110:111]
    v_pk_add_f32 v[206:207], v[206:207], v[122:123]
    v_pk_add_f32 v[208:209], v[208:209], v[122:123]
    v_rcp_f32 v206, v206
    v_rcp_f32 v207, v207
    v_rcp_f32 v208, v208
    v_rcp_f32 v209, v209
    v_pk_mul_f32 v[210:211], v[210:211], v[206:207]
    v_pk_mul_f32 v[212:213], v[212:213], v[208:209]
    v_cvt_pk_bf16_f32 v202, v210, v211
    v_cvt_pk_bf16_f32 v203, v212, v213
    s_cmp_eq_u32 s38, 1
    s_cbranch_scc1 F_WM1_2
    buffer_store_dwordx4 v[190:193], v121, s[16:19], s34 offen offset:0 sc1
    buffer_store_dwordx4 v[194:197], v121, s[16:19], s34 offen offset:512 sc1
    buffer_store_dwordx4 v[198:201], v121, s[16:19], s34 offen offset:1024 sc1
    buffer_store_dwordx2 v[202:203], v121, s[16:19], s34 offen offset:1536 sc1
    s_branch F_ST_3
F_WM1_2:
    buffer_store_dwordx2 v[190:191], v121, s[16:19], s34 offen offset:1544 sc1
    buffer_store_dwordx4 v[192:195], v121, s[16:19], s34 offen offset:2048 sc1
    buffer_store_dwordx4 v[196:199], v121, s[16:19], s34 offen offset:2560 sc1
    buffer_store_dwordx4 v[200:203], v121, s[16:19], s34 offen offset:3072 sc1
F_ST_3:
    v_permlane32_swap_b32 v16, v20
    v_permlane32_swap_b32 v17, v21
    v_permlane32_swap_b32 v18, v22
    v_permlane32_swap_b32 v19, v23
    v_permlane32_swap_b32 v32, v36
    v_permlane32_swap_b32 v33, v37
    v_permlane32_swap_b32 v34, v38
    v_permlane32_swap_b32 v35, v39
    v_pk_fma_f32 v[16:17], v[124:125], v[182:183], v[16:17] op_sel_hi:[1,0,1] neg_lo:[0,1,0] neg_hi:[0,1,0]
    v_pk_fma_f32 v[20:21], v[152:153], v[182:183], v[20:21] op_sel_hi:[1,0,1] neg_lo:[0,1,0] neg_hi:[0,1,0]
    v_pk_fma_f32 v[18:19], v[126:127], v[182:183], v[18:19] op_sel_hi:[1,0,1] neg_lo:[0,1,0] neg_hi:[0,1,0]
    v_pk_fma_f32 v[22:23], v[154:155], v[182:183], v[22:23] op_sel_hi:[1,0,1] neg_lo:[0,1,0] neg_hi:[0,1,0]
    v_pk_fma_f32 v[32:33], v[128:129], v[182:183], v[32:33] op_sel_hi:[1,0,1] neg_lo:[0,1,0] neg_hi:[0,1,0]
    v_pk_fma_f32 v[36:37], v[156:157], v[182:183], v[36:37] op_sel_hi:[1,0,1] neg_lo:[0,1,0] neg_hi:[0,1,0]
    v_pk_fma_f32 v[34:35], v[130:131], v[182:183], v[34:35] op_sel_hi:[1,0,1] neg_lo:[0,1,0] neg_hi:[0,1,0]
    v_pk_fma_f32 v[38:39], v[158:159], v[182:183], v[38:39] op_sel_hi:[1,0,1] neg_lo:[0,1,0] neg_hi:[0,1,0]
    v_pk_mul_f32 v[206:207], v[16:17], v[186:187] op_sel_hi:[1,0]
    v_pk_mul_f32 v[208:209], v[18:19], v[186:187] op_sel_hi:[1,0]
    v_pk_mul_f32 v[214:215], v[32:33], v[186:187] op_sel_hi:[1,0]
    v_pk_mul_f32 v[216:217], v[34:35], v[186:187] op_sel_hi:[1,0]
    v_exp_f32 v206, v206
    v_exp_f32 v207, v207
    v_exp_f32 v208, v208
    v_exp_f32 v209, v209
    v_exp_f32 v214, v214
    v_exp_f32 v215, v215
    v_exp_f32 v216, v216
    v_exp_f32 v217, v217
    v_pk_mul_f32 v[210:211], v[16:17], v[20:21]
    v_pk_mul_f32 v[212:213], v[18:19], v[22:23]
    v_pk_mul_f32 v[218:219], v[32:33], v[36:37]
    v_pk_mul_f32 v[220:221], v[34:35], v[38:39]
    v_pk_add_f32 v[206:207], v[206:207], v[122:123]
    v_pk_add_f32 v[208:209], v[208:209], v[122:123]
    v_pk_add_f32 v[214:215], v[214:215], v[122:123]
    v_pk_add_f32 v[216:217], v[216:217], v[122:123]
    v_rcp_f32 v206, v206
    v_rcp_f32 v207, v207
    v_rcp_f32 v208, v208
    v_rcp_f32 v209, v209
    v_rcp_f32 v214, v214
    v_rcp_f32 v215, v215
    v_rcp_f32 v216, v216
    v_rcp_f32 v217, v217
    v_pk_mul_f32 v[210:211], v[210:211], v[206:207]
    v_pk_mul_f32 v[212:213], v[212:213], v[208:209]
    v_pk_mul_f32 v[218:219], v[218:219], v[214:215]
    v_pk_mul_f32 v[220:221], v[220:221], v[216:217]
    v_cvt_pk_bf16_f32 v190, v210, v211
    v_cvt_pk_bf16_f32 v191, v212, v213
    v_cvt_pk_bf16_f32 v192, v218, v219
    v_cvt_pk_bf16_f32 v193, v220, v221
    v_permlane32_swap_b32 v48, v52
    v_permlane32_swap_b32 v49, v53
    v_permlane32_swap_b32 v50, v54
    v_permlane32_swap_b32 v51, v55
    v_permlane32_swap_b32 v64, v68
    v_permlane32_swap_b32 v65, v69
    v_permlane32_swap_b32 v66, v70
    v_permlane32_swap_b32 v67, v71
    v_pk_fma_f32 v[48:49], v[132:133], v[182:183], v[48:49] op_sel_hi:[1,0,1] neg_lo:[0,1,0] neg_hi:[0,1,0]
    v_pk_fma_f32 v[52:53], v[160:161], v[182:183], v[52:53] op_sel_hi:[1,0,1] neg_lo:[0,1,0] neg_hi:[0,1,0]
    v_pk_fma_f32 v[50:51], v[134:135], v[182:183], v[50:51] op_sel_hi:[1,0,1] neg_lo:[0,1,0] neg_hi:[0,1,0]
    v_pk_fma_f32 v[54:55], v[162:163], v[182:183], v[54:55] op_sel_hi:[1,0,1] neg_lo:[0,1,0] neg_hi:[0,1,0]
    v_pk_fma_f32 v[64:65], v[136:137], v[182:183], v[64:65] op_sel_hi:[1,0,1] neg_lo:[0,1,0] neg_hi:[0,1,0]
    v_pk_fma_f32 v[68:69], v[164:165], v[182:183], v[68:69] op_sel_hi:[1,0,1] neg_lo:[0,1,0] neg_hi:[0,1,0]
    v_pk_fma_f32 v[66:67], v[138:139], v[182:183], v[66:67] op_sel_hi:[1,0,1] neg_lo:[0,1,0] neg_hi:[0,1,0]
    v_pk_fma_f32 v[70:71], v[166:167], v[182:183], v[70:71] op_sel_hi:[1,0,1] neg_lo:[0,1,0] neg_hi:[0,1,0]
    v_pk_mul_f32 v[206:207], v[48:49], v[186:187] op_sel_hi:[1,0]
    v_pk_mul_f32 v[208:209], v[50:51], v[186:187] op_sel_hi:[1,0]
    v_pk_mul_f32 v[214:215], v[64:65], v[186:187] op_sel_hi:[1,0]
    v_pk_mul_f32 v[216:217], v[66:67], v[186:187] op_sel_hi:[1,0]
    v_exp_f32 v206, v206
    v_exp_f32 v207, v207
    v_exp_f32 v208, v208
    v_exp_f32 v209, v209
    v_exp_f32 v214, v214
    v_exp_f32 v215, v215
    v_exp_f32 v216, v216
    v_exp_f32 v217, v217
    v_pk_mul_f32 v[210:211], v[48:49], v[52:53]
    v_pk_mul_f32 v[212:213], v[50:51], v[54:55]
    v_pk_mul_f32 v[218:219], v[64:65], v[68:69]
    v_pk_mul_f32 v[220:221], v[66:67], v[70:71]
    v_pk_add_f32 v[206:207], v[206:207], v[122:123]
    v_pk_add_f32 v[208:209], v[208:209], v[122:123]
    v_pk_add_f32 v[214:215], v[214:215], v[122:123]
    v_pk_add_f32 v[216:217], v[216:217], v[122:123]
    v_rcp_f32 v206, v206
    v_rcp_f32 v207, v207
    v_rcp_f32 v208, v208
    v_rcp_f32 v209, v209
    v_rcp_f32 v214, v214
    v_rcp_f32 v215, v215
    v_rcp_f32 v216, v216
    v_rcp_f32 v217, v217
    v_pk_mul_f32 v[210:211], v[210:211], v[206:207]
    v_pk_mul_f32 v[212:213], v[212:213], v[208:209]
    v_pk_mul_f32 v[218:219], v[218:219], v[214:215]
    v_pk_mul_f32 v[220:221], v[220:221], v[216:217]
    v_cvt_pk_bf16_f32 v194, v210, v211
    v_cvt_pk_bf16_f32 v195, v212, v213
    v_cvt_pk_bf16_f32 v196, v218, v219
    v_cvt_pk_bf16_f32 v197, v220, v221
    v_permlane32_swap_b32 v80, v84
    v_permlane32_swap_b32 v81, v85
    v_permlane32_swap_b32 v82, v86
    v_permlane32_swap_b32 v83, v87
    v_permlane32_swap_b32 v96, v100
    v_permlane32_swap_b32 v97, v101
    v_permlane32_swap_b32 v98, v102
    v_permlane32_swap_b32 v99, v103
    v_pk_fma_f32 v[80:81], v[140:141], v[182:183], v[80:81] op_sel_hi:[1,0,1] neg_lo:[0,1,0] neg_hi:[0,1,0]
    v_pk_fma_f32 v[84:85], v[168:169], v[182:183], v[84:85] op_sel_hi:[1,0,1] neg_lo:[0,1,0] neg_hi:[0,1,0]
    v_pk_fma_f32 v[82:83], v[142:143], v[182:183], v[82:83] op_sel_hi:[1,0,1] neg_lo:[0,1,0] neg_hi:[0,1,0]
    v_pk_fma_f32 v[86:87], v[170:171], v[182:183], v[86:87] op_sel_hi:[1,0,1] neg_lo:[0,1,0] neg_hi:[0,1,0]
    v_pk_fma_f32 v[96:97], v[144:145], v[182:183], v[96:97] op_sel_hi:[1,0,1] neg_lo:[0,1,0] neg_hi:[0,1,0]
    v_pk_fma_f32 v[100:101], v[172:173], v[182:183], v[100:101] op_sel_hi:[1,0,1] neg_lo:[0,1,0] neg_hi:[0,1,0]
    v_pk_fma_f32 v[98:99], v[146:147], v[182:183], v[98:99] op_sel_hi:[1,0,1] neg_lo:[0,1,0] neg_hi:[0,1,0]
    v_pk_fma_f32 v[102:103], v[174:175], v[182:183], v[102:103] op_sel_hi:[1,0,1] neg_lo:[0,1,0] neg_hi:[0,1,0]
    v_pk_mul_f32 v[206:207], v[80:81], v[186:187] op_sel_hi:[1,0]
    v_pk_mul_f32 v[208:209], v[82:83], v[186:187] op_sel_hi:[1,0]
    v_pk_mul_f32 v[214:215], v[96:97], v[186:187] op_sel_hi:[1,0]
    v_pk_mul_f32 v[216:217], v[98:99], v[186:187] op_sel_hi:[1,0]
    v_exp_f32 v206, v206
    v_exp_f32 v207, v207
    v_exp_f32 v208, v208
    v_exp_f32 v209, v209
    v_exp_f32 v214, v214
    v_exp_f32 v215, v215
    v_exp_f32 v216, v216
    v_exp_f32 v217, v217
    v_pk_mul_f32 v[210:211], v[80:81], v[84:85]
    v_pk_mul_f32 v[212:213], v[82:83], v[86:87]
    v_pk_mul_f32 v[218:219], v[96:97], v[100:101]
    v_pk_mul_f32 v[220:221], v[98:99], v[102:103]
    v_pk_add_f32 v[206:207], v[206:207], v[122:123]
    v_pk_add_f32 v[208:209], v[208:209], v[122:123]
    v_pk_add_f32 v[214:215], v[214:215], v[122:123]
    v_pk_add_f32 v[216:217], v[216:217], v[122:123]
    v_rcp_f32 v206, v206
    v_rcp_f32 v207, v207
    v_rcp_f32 v208, v208
    v_rcp_f32 v209, v209
    v_rcp_f32 v214, v214
    v_rcp_f32 v215, v215
    v_rcp_f32 v216, v216
    v_rcp_f32 v217, v217
    v_pk_mul_f32 v[210:211], v[210:211], v[206:207]
    v_pk_mul_f32 v[212:213], v[212:213], v[208:209]
    v_pk_mul_f32 v[218:219], v[218:219], v[214:215]
    v_pk_mul_f32 v[220:221], v[220:221], v[216:217]
    v_cvt_pk_bf16_f32 v198, v210, v211
    v_cvt_pk_bf16_f32 v199, v212, v213
    v_cvt_pk_bf16_f32 v200, v218, v219
    v_cvt_pk_bf16_f32 v201, v220, v221
    v_permlane32_swap_b32 v112, v116
    v_permlane32_swap_b32 v113, v117
    v_permlane32_swap_b32 v114, v118
    v_permlane32_swap_b32 v115, v119
    v_pk_fma_f32 v[112:113], v[148:149], v[182:183], v[112:113] op_sel_hi:[1,0,1] neg_lo:[0,1,0] neg_hi:[0,1,0]
    v_pk_fma_f32 v[116:117], v[176:177], v[182:183], v[116:117] op_sel_hi:[1,0,1] neg_lo:[0,1,0] neg_hi:[0,1,0]
    v_pk_fma_f32 v[114:115], v[150:151], v[182:183], v[114:115] op_sel_hi:[1,0,1] neg_lo:[0,1,0] neg_hi:[0,1,0]
    v_pk_fma_f32 v[118:119], v[178:179], v[182:183], v[118:119] op_sel_hi:[1,0,1] neg_lo:[0,1,0] neg_hi:[0,1,0]
    v_pk_mul_f32 v[206:207], v[112:113], v[186:187] op_sel_hi:[1,0]
    v_pk_mul_f32 v[208:209], v[114:115], v[186:187] op_sel_hi:[1,0]
    v_exp_f32 v206, v206
    v_exp_f32 v207, v207
    v_exp_f32 v208, v208
    v_exp_f32 v209, v209
    v_pk_mul_f32 v[210:211], v[112:113], v[116:117]
    v_pk_mul_f32 v[212:213], v[114:115], v[118:119]
    v_pk_add_f32 v[206:207], v[206:207], v[122:123]
    v_pk_add_f32 v[208:209], v[208:209], v[122:123]
    v_rcp_f32 v206, v206
    v_rcp_f32 v207, v207
    v_rcp_f32 v208, v208
    v_rcp_f32 v209, v209
    v_pk_mul_f32 v[210:211], v[210:211], v[206:207]
    v_pk_mul_f32 v[212:213], v[212:213], v[208:209]
    v_cvt_pk_bf16_f32 v202, v210, v211
    v_cvt_pk_bf16_f32 v203, v212, v213
    s_cmp_eq_u32 s38, 1
    s_cbranch_scc1 F_WM1_4
    buffer_store_dwordx4 v[190:193], v121, s[16:19], s35 offen offset:0 sc1
    buffer_store_dwordx4 v[194:197], v121, s[16:19], s35 offen offset:512 sc1
    buffer_store_dwordx4 v[198:201], v121, s[16:19], s35 offen offset:1024 sc1
    buffer_store_dwordx2 v[202:203], v121, s[16:19], s35 offen offset:1536 sc1
    s_branch F_ST_5
F_WM1_4:
    buffer_store_dwordx2 v[190:191], v121, s[16:19], s35 offen offset:1544 sc1
    buffer_store_dwordx4 v[192:195], v121, s[16:19], s35 offen offset:2048 sc1
    buffer_store_dwordx4 v[196:199], v121, s[16:19], s35 offen offset:2560 sc1
    buffer_store_dwordx4 v[200:203], v121, s[16:19], s35 offen offset:3072 sc1
F_ST_5:
    v_mov_b32 v6, 1
    s_mov_b64 exec, 1
    ds_add_u32 v5, v6 offset:60
    s_mov_b64 exec, -1
    v_lshlrev_b32 v104, 4, v1
    v_bfe_u32 v2, v1, 5, 1
    v_lshlrev_b32 v2, 4, v2
    v_bfe_u32 v3, v1, 4, 1
    v_lshl_add_u32 v2, v3, 2, v2
    v_bfe_u32 v4, v1, 2, 2
    v_add_u32 v2, v2, v4
    v_lshlrev_b32 v2, 7, v2
    v_lshrrev_b32 v4, 1, v4
    v_lshl_add_u32 v3, v3, 1, v4
    v_and_b32 v4, 3, v1
    v_lshl_add_u32 v2, v4, 3, v2
    v_add_u32 v2, s43, v2
    v_xor_b32 v4, 0, v3
    v_lshl_add_u32 v105, v4, 5, v2
    v_xor_b32 v4, 1, v3
    v_lshl_add_u32 v106, v4, 5, v2
    v_xor_b32 v4, 2, v3
    v_lshl_add_u32 v107, v4, 5, v2
    v_xor_b32 v4, 3, v3
    v_lshl_add_u32 v108, v4, 5, v2
    v_mov_b32 v8, 0
    v_mov_b32 v9, 0
    v_mov_b32 v10, 0
    v_mov_b32 v11, 0
    v_mov_b32 v12, 0
    v_mov_b32 v13, 0
    v_mov_b32 v14, 0
    v_mov_b32 v15, 0
    v_mov_b32 v16, 0
    v_mov_b32 v17, 0
    v_mov_b32 v18, 0
    v_mov_b32 v19, 0
    v_mov_b32 v20, 0
    v_mov_b32 v21, 0
    v_mov_b32 v22, 0
    v_mov_b32 v23, 0
    v_mov_b32 v24, 0
    v_mov_b32 v25, 0
    v_mov_b32 v26, 0
    v_mov_b32 v27, 0
    v_mov_b32 v28, 0
    v_mov_b32 v29, 0
    v_mov_b32 v30, 0
    v_mov_b32 v31, 0
    v_mov_b32 v32, 0
    v_mov_b32 v33, 0
    v_mov_b32 v34, 0
    v_mov_b32 v35, 0
    v_mov_b32 v36, 0
    v_mov_b32 v37, 0
    v_mov_b32 v38, 0
    v_mov_b32 v39, 0
    v_mov_b32 v40, 0
    v_mov_b32 v41, 0
    v_mov_b32 v42, 0
    v_mov_b32 v43, 0
    v_mov_b32 v44, 0
    v_mov_b32 v45, 0
    v_mov_b32 v46, 0
    v_mov_b32 v47, 0
    v_mov_b32 v48, 0
    v_mov_b32 v49, 0
    v_mov_b32 v50, 0
    v_mov_b32 v51, 0
    v_mov_b32 v52, 0
    v_mov_b32 v53, 0
    v_mov_b32 v54, 0
    v_mov_b32 v55, 0
    v_mov_b32 v56, 0
    v_mov_b32 v57, 0
    v_mov_b32 v58, 0
    v_mov_b32 v59, 0
    v_mov_b32 v60, 0
    v_mov_b32 v61, 0
    v_mov_b32 v62, 0
    v_mov_b32 v63, 0
    v_mov_b32 v64, 0
    v_mov_b32 v65, 0
    v_mov_b32 v66, 0
    v_mov_b32 v67, 0
    v_mov_b32 v68, 0
    v_mov_b32 v69, 0
    v_mov_b32 v70, 0
    v_mov_b32 v71, 0
    s_lshl_b32 s32, s30, 2
    s_mul_i32 s32, s32, 57472
    s_mul_i32 s33, s3, 14336
    s_add_u32 s32, s32, s33
    s_add_u32 s44, s32, 3145728
    v_and_b32 v2, 3, v1
    s_lshl_b32 s32, s31, 2
    v_add_u32 v2, s32, v2
    v_lshrrev_b32 v3, 3, v2
    s_mov_b32 s32, 57472
    v_mul_lo_u32 v3, v3, s32
    v_and_b32 v2, 7, v2
    v_lshl_add_u32 v3, v2, 7, v3
    v_lshrrev_b32 v2, 2, v1
    v_min_u32 v2, 13, v2
    v_lshl_add_u32 v109, v2, 10, v3
    v_lshrrev_b32 v110, 2, v1
    v_lshlrev_b32 v110, 6, v110
    v_and_b32 v2, 3, v1
    v_lshl_add_u32 v110, v2, 2, v110
    s_waitcnt vmcnt(0)
    v_mov_b32 v111, 1
    s_mov_b64 exec, 1
    ds_add_rtn_u32 v112, v5, v111 offset:36
    s_waitcnt lgkmcnt(0)
    v_readfirstlane_b32 s32, v112
    s_mov_b64 exec, -1
    s_cmp_eq_u32 s32, 3
    s_cbranch_scc0 F_PB_6
    s_lshl_b32 s32, s28, 8
    s_lshr_b32 s33, s29, 2
    s_lshl_b32 s33, s33, 6
    s_add_u32 s32, s32, s33
    s_and_b32 s33, s29, 3
    s_lshl_b32 s33, s33, 2
    s_add_u32 s32, s32, s33
    s_add_u32 s32, s32, 13705216
    v_mov_b32 v111, 0
    v_mov_b32 v112, s37
    s_mov_b64 exec, 1
    buffer_store_dword v112, v111, s[16:19], s32 offen sc1
    s_mov_b64 exec, -1
F_PB_6:
    s_add_u32 m0, s43, 0
    s_add_u32 s32, s45, 0
    buffer_load_dwordx4 v120, s[20:23], s32 offen lds
    s_add_u32 m0, s43, 1024
    s_add_u32 s32, s45, 8192
    buffer_load_dwordx4 v120, s[20:23], s32 offen lds
    s_add_u32 m0, s43, 2048
    s_add_u32 s32, s45, 16384
    buffer_load_dwordx4 v120, s[20:23], s32 offen lds
    s_add_u32 m0, s43, 3072
    s_add_u32 s32, s45, 24576
    buffer_load_dwordx4 v120, s[20:23], s32 offen lds
    s_add_u32 m0, s43, 4096
    s_add_u32 s32, s45, 32768
    buffer_load_dwordx4 v120, s[20:23], s32 offen lds
    s_add_u32 m0, s43, 5120
    s_add_u32 s32, s45, 40960
    buffer_load_dwordx4 v120, s[20:23], s32 offen lds
    s_add_u32 m0, s43, 6144
    s_add_u32 s32, s45, 49152
    buffer_load_dwordx4 v120, s[20:23], s32 offen lds
    s_add_u32 m0, s43, 7168
    s_add_u32 s32, s45, 57344
    buffer_load_dwordx4 v120, s[20:23], s32 offen lds
    s_add_u32 m0, s43, 8192
    s_add_u32 s32, s45, 65536
    buffer_load_dwordx4 v120, s[20:23], s32 offen lds
    s_add_u32 m0, s43, 9216
    s_add_u32 s32, s45, 73728
    buffer_load_dwordx4 v120, s[20:23], s32 offen lds
    s_add_u32 m0, s43, 10240
    s_add_u32 s32, s45, 81920
    buffer_load_dwordx4 v120, s[20:23], s32 offen lds
    s_add_u32 m0, s43, 11264
    s_add_u32 s32, s45, 90112
    buffer_load_dwordx4 v120, s[20:23], s32 offen lds
    s_add_u32 m0, s43, 12288
    s_add_u32 s32, s45, 98304
    buffer_load_dwordx4 v120, s[20:23], s32 offen lds
    s_add_u32 m0, s43, 13312
    s_add_u32 s32, s45, 106496
    buffer_load_dwordx4 v120, s[20:23], s32 offen lds
    s_add_u32 m0, s43, 14336
    s_add_u32 s32, s45, 114688
    buffer_load_dwordx4 v120, s[20:23], s32 offen lds
    s_add_u32 m0, s43, 15360
    s_add_u32 s32, s45, 122880
    buffer_load_dwordx4 v120, s[20:23], s32 offen lds
    s_add_u32 m0, s43, 16384
    s_add_u32 s32, s45, 131072
    buffer_load_dwordx4 v120, s[20:23], s32 offen lds
    s_add_u32 m0, s43, 17408
    s_add_u32 s32, s45, 139264
    buffer_load_dwordx4 v120, s[20:23], s32 offen lds
    s_add_u32 m0, s43, 18432
    s_add_u32 s32, s45, 147456
    buffer_load_dwordx4 v120, s[20:23], s32 offen lds
    s_add_u32 m0, s43, 19456
    s_add_u32 s32, s45, 155648
    buffer_load_dwordx4 v120, s[20:23], s32 offen lds
    s_waitcnt vmcnt(0)
    ds_read_b64_tr_b16 v[188:189], v105 offset:0
    ds_read_b64_tr_b16 v[190:191], v105 offset:1024
    ds_read_b64_tr_b16 v[192:193], v106 offset:0
    ds_read_b64_tr_b16 v[194:195], v106 offset:1024
    ds_read_b64_tr_b16 v[196:197], v107 offset:0
    ds_read_b64_tr_b16 v[198:199], v107 offset:1024
    ds_read_b64_tr_b16 v[200:201], v108 offset:0
    ds_read_b64_tr_b16 v[202:203], v108 offset:1024
    ds_read_b64_tr_b16 v[204:205], v105 offset:4096
    ds_read_b64_tr_b16 v[206:207], v105 offset:5120
    ds_read_b64_tr_b16 v[208:209], v106 offset:4096
    ds_read_b64_tr_b16 v[210:211], v106 offset:5120
    ds_read_b64_tr_b16 v[212:213], v107 offset:4096
    ds_read_b64_tr_b16 v[214:215], v107 offset:5120
    ds_read_b64_tr_b16 v[216:217], v108 offset:4096
    ds_read_b64_tr_b16 v[218:219], v108 offset:5120
    ds_read_b64_tr_b16 v[220:221], v105 offset:8192
    ds_read_b64_tr_b16 v[222:223], v105 offset:9216
    ds_read_b64_tr_b16 v[224:225], v106 offset:8192
    ds_read_b64_tr_b16 v[226:227], v106 offset:9216
    ds_read_b64_tr_b16 v[228:229], v107 offset:8192
    ds_read_b64_tr_b16 v[230:231], v107 offset:9216
    ds_read_b64_tr_b16 v[232:233], v108 offset:8192
    ds_read_b64_tr_b16 v[234:235], v108 offset:9216
    ds_read_b64_tr_b16 v[236:237], v105 offset:12288
    ds_read_b64_tr_b16 v[238:239], v105 offset:13312
    ds_read_b64_tr_b16 v[240:241], v106 offset:12288
    ds_read_b64_tr_b16 v[242:243], v106 offset:13312
    ds_read_b64_tr_b16 v[244:245], v107 offset:12288
    ds_read_b64_tr_b16 v[246:247], v107 offset:13312
    ds_read_b64_tr_b16 v[248:249], v108 offset:12288
    ds_read_b64_tr_b16 v[250:251], v108 offset:13312
    s_waitcnt lgkmcnt(0)
    s_add_u32 m0, s43, 0
    s_add_u32 s32, s45, 163840
    buffer_load_dwordx4 v120, s[20:23], s32 offen lds
    s_add_u32 m0, s43, 1024
    s_add_u32 s32, s45, 172032
    buffer_load_dwordx4 v120, s[20:23], s32 offen lds
    s_add_u32 m0, s43, 2048
    s_add_u32 s32, s45, 180224
    buffer_load_dwordx4 v120, s[20:23], s32 offen lds
    s_add_u32 m0, s43, 3072
    s_add_u32 s32, s45, 188416
    buffer_load_dwordx4 v120, s[20:23], s32 offen lds
    s_add_u32 m0, s43, 4096
    s_add_u32 s32, s45, 196608
    buffer_load_dwordx4 v120, s[20:23], s32 offen lds
    s_add_u32 m0, s43, 5120
    s_add_u32 s32, s45, 204800
    buffer_load_dwordx4 v120, s[20:23], s32 offen lds
    s_add_u32 m0, s43, 6144
    s_add_u32 s32, s45, 212992
    buffer_load_dwordx4 v120, s[20:23], s32 offen lds
    s_add_u32 m0, s43, 7168
    s_add_u32 s32, s45, 221184
    buffer_load_dwordx4 v120, s[20:23], s32 offen lds
    s_add_u32 m0, s43, 8192
    s_add_u32 s32, s45, 229376
    buffer_load_dwordx4 v120, s[20:23], s32 offen lds
    s_add_u32 m0, s43, 9216
    s_add_u32 s32, s45, 237568
    buffer_load_dwordx4 v120, s[20:23], s32 offen lds
    s_add_u32 m0, s43, 10240
    s_add_u32 s32, s45, 245760
    buffer_load_dwordx4 v120, s[20:23], s32 offen lds
    s_add_u32 m0, s43, 11264
    s_add_u32 s32, s45, 253952
    buffer_load_dwordx4 v120, s[20:23], s32 offen lds
    s_add_u32 m0, s43, 12288
    s_add_u32 s32, s45, 262144
    buffer_load_dwordx4 v120, s[20:23], s32 offen lds
    s_add_u32 m0, s43, 13312
    s_add_u32 s32, s45, 270336
    buffer_load_dwordx4 v120, s[20:23], s32 offen lds
    s_add_u32 m0, s43, 14336
    s_add_u32 s32, s45, 278528
    buffer_load_dwordx4 v120, s[20:23], s32 offen lds
    s_add_u32 m0, s43, 15360
    s_add_u32 s32, s45, 286720
    buffer_load_dwordx4 v120, s[20:23], s32 offen lds
    s_lshr_b32 s32, s30, 1
    s_lshl_b32 s32, s32, 8
    s_add_u32 s32, s32, 13705216
    s_cmp_eq_u32 s3, 0
    s_cbranch_scc0 F_PB2_7
    s_mov_b32 s33, 0
    s_mov_b64 exec, 0xffff
POLL_9:
    buffer_load_dword v111, v110, s[16:19], s32 offen sc1
    s_waitcnt vmcnt(0)
    v_cmp_ne_u32 vcc, s37, v111
    s_nop 4
    s_cbranch_vccz POLLD_10
    s_sleep 2
    s_add_u32 s33, s33, 1
    s_cmp_lt_u32 s33, 65536
    s_cbranch_scc1 POLL_9
POLLD_10:
    s_mov_b64 exec, -1
    v_mov_b32 v6, 1
    s_mov_b64 exec, 1
    ds_add_u32 v5, v6 offset:52
    s_mov_b64 exec, -1
    s_branch F_PB3_8
F_PB2_7:
GS_11:
    ds_read_b32 v6, v5 offset:52
    s_waitcnt lgkmcnt(0)
    v_readfirstlane_b32 s46, v6
    s_nop 0
    s_cmp_lt_u32 s46, 1
    s_cbranch_scc1 GS_11
F_PB3_8:
    s_mov_b32 exec_hi, 0xffffff
    buffer_load_dword v7, v109, s[16:19], s44 offen
    s_mov_b64 exec, -1
    s_add_u32 s32, s44, 0
    buffer_load_dwordx4 v[124:127], v104, s[16:19], s32 offen
    s_add_u32 s32, s44, 57472
    buffer_load_dwordx4 v[128:131], v104, s[16:19], s32 offen
    s_add_u32 s32, s44, 114944
    buffer_load_dwordx4 v[132:135], v104, s[16:19], s32 offen
    s_add_u32 s32, s44, 172416
    buffer_load_dwordx4 v[136:139], v104, s[16:19], s32 offen
    s_add_u32 s32, s44, 1024
    buffer_load_dwordx4 v[140:143], v104, s[16:19], s32 offen
    s_add_u32 s32, s44, 58496
    buffer_load_dwordx4 v[144:147], v104, s[16:19], s32 offen
    s_add_u32 s32, s44, 115968
    buffer_load_dwordx4 v[148:151], v104, s[16:19], s32 offen
    s_add_u32 s32, s44, 173440
    buffer_load_dwordx4 v[152:155], v104, s[16:19], s32 offen
    s_add_u32 s32, s44, 2048
    buffer_load_dwordx4 v[156:159], v104, s[16:19], s32 offen
    s_add_u32 s32, s44, 59520
    buffer_load_dwordx4 v[160:163], v104, s[16:19], s32 offen
    s_add_u32 s32, s44, 116992
    buffer_load_dwordx4 v[164:167], v104, s[16:19], s32 offen
    s_add_u32 s32, s44, 174464
    buffer_load_dwordx4 v[168:171], v104, s[16:19], s32 offen
    s_add_u32 s32, s44, 3072
    buffer_load_dwordx4 v[172:175], v104, s[16:19], s32 offen
    s_add_u32 s32, s44, 60544
    buffer_load_dwordx4 v[176:179], v104, s[16:19], s32 offen
    s_add_u32 s32, s44, 118016
    buffer_load_dwordx4 v[180:183], v104, s[16:19], s32 offen
    s_add_u32 s32, s44, 175488
    buffer_load_dwordx4 v[184:187], v104, s[16:19], s32 offen
    v_and_b32 v111, 15, v1
    v_lshrrev_b32 v112, 4, v1
    v_lshlrev_b32 v113, 10, v111
    v_lshl_add_u32 v113, v112, 3, v113
    v_lshlrev_b32 v115, 3, v111
    v_lshrrev_b32 v114, 2, v1
    v_lshlrev_b32 v114, 12, v114
    v_and_b32 v3, 3, v1
    v_lshl_add_u32 v114, v3, 5, v114
    s_lshl_b32 s35, s30, 16
    s_lshl_b32 s34, s31, 7
    s_add_u32 s35, s35, s34
    s_lshl_b32 s34, s3, 5
    s_add_u32 s35, s35, s34
    s_waitcnt vmcnt(12)
    s_waitcnt lgkmcnt(0)
    v_mfma_f32_16x16x32_bf16 v[8:11], v[188:191], v[124:127], v[8:11]
    v_mfma_f32_16x16x32_bf16 v[24:27], v[192:195], v[124:127], v[24:27]
    v_mfma_f32_16x16x32_bf16 v[40:43], v[196:199], v[124:127], v[40:43]
    v_mfma_f32_16x16x32_bf16 v[56:59], v[200:203], v[124:127], v[56:59]
    s_add_u32 s32, s44, 4096
    buffer_load_dwordx4 v[124:127], v104, s[16:19], s32 offen
    v_mfma_f32_16x16x32_bf16 v[12:15], v[188:191], v[128:131], v[12:15]
    v_mfma_f32_16x16x32_bf16 v[28:31], v[192:195], v[128:131], v[28:31]
    v_mfma_f32_16x16x32_bf16 v[44:47], v[196:199], v[128:131], v[44:47]
    v_mfma_f32_16x16x32_bf16 v[60:63], v[200:203], v[128:131], v[60:63]
    s_add_u32 s32, s44, 61568
    buffer_load_dwordx4 v[128:131], v104, s[16:19], s32 offen
    v_mfma_f32_16x16x32_bf16 v[16:19], v[188:191], v[132:135], v[16:19]
    v_mfma_f32_16x16x32_bf16 v[32:35], v[192:195], v[132:135], v[32:35]
    v_mfma_f32_16x16x32_bf16 v[48:51], v[196:199], v[132:135], v[48:51]
    v_mfma_f32_16x16x32_bf16 v[64:67], v[200:203], v[132:135], v[64:67]
    s_add_u32 s32, s44, 119040
    buffer_load_dwordx4 v[132:135], v104, s[16:19], s32 offen
    v_mfma_f32_16x16x32_bf16 v[20:23], v[188:191], v[136:139], v[20:23]
    v_mfma_f32_16x16x32_bf16 v[36:39], v[192:195], v[136:139], v[36:39]
    v_mfma_f32_16x16x32_bf16 v[52:55], v[196:199], v[136:139], v[52:55]
    v_mfma_f32_16x16x32_bf16 v[68:71], v[200:203], v[136:139], v[68:71]
    s_add_u32 s32, s44, 176512
    buffer_load_dwordx4 v[136:139], v104, s[16:19], s32 offen
    s_waitcnt vmcnt(12)
    s_waitcnt lgkmcnt(0)
    v_mfma_f32_16x16x32_bf16 v[8:11], v[204:207], v[140:143], v[8:11]
    v_mfma_f32_16x16x32_bf16 v[24:27], v[208:211], v[140:143], v[24:27]
    v_mfma_f32_16x16x32_bf16 v[40:43], v[212:215], v[140:143], v[40:43]
    v_mfma_f32_16x16x32_bf16 v[56:59], v[216:219], v[140:143], v[56:59]
    s_add_u32 s32, s44, 5120
    buffer_load_dwordx4 v[140:143], v104, s[16:19], s32 offen
    v_mfma_f32_16x16x32_bf16 v[12:15], v[204:207], v[144:147], v[12:15]
    v_mfma_f32_16x16x32_bf16 v[28:31], v[208:211], v[144:147], v[28:31]
    v_mfma_f32_16x16x32_bf16 v[44:47], v[212:215], v[144:147], v[44:47]
    v_mfma_f32_16x16x32_bf16 v[60:63], v[216:219], v[144:147], v[60:63]
    s_add_u32 s32, s44, 62592
    buffer_load_dwordx4 v[144:147], v104, s[16:19], s32 offen
    v_mfma_f32_16x16x32_bf16 v[16:19], v[204:207], v[148:151], v[16:19]
    v_mfma_f32_16x16x32_bf16 v[32:35], v[208:211], v[148:151], v[32:35]
    v_mfma_f32_16x16x32_bf16 v[48:51], v[212:215], v[148:151], v[48:51]
    v_mfma_f32_16x16x32_bf16 v[64:67], v[216:219], v[148:151], v[64:67]
    s_add_u32 s32, s44, 120064
    buffer_load_dwordx4 v[148:151], v104, s[16:19], s32 offen
    v_mfma_f32_16x16x32_bf16 v[20:23], v[204:207], v[152:155], v[20:23]
    v_mfma_f32_16x16x32_bf16 v[36:39], v[208:211], v[152:155], v[36:39]
    v_mfma_f32_16x16x32_bf16 v[52:55], v[212:215], v[152:155], v[52:55]
    v_mfma_f32_16x16x32_bf16 v[68:71], v[216:219], v[152:155], v[68:71]
    s_add_u32 s32, s44, 177536
    buffer_load_dwordx4 v[152:155], v104, s[16:19], s32 offen
    s_waitcnt vmcnt(12)
    s_waitcnt lgkmcnt(0)
    v_mfma_f32_16x16x32_bf16 v[8:11], v[220:223], v[156:159], v[8:11]
    v_mfma_f32_16x16x32_bf16 v[24:27], v[224:227], v[156:159], v[24:27]
    v_mfma_f32_16x16x32_bf16 v[40:43], v[228:231], v[156:159], v[40:43]
    v_mfma_f32_16x16x32_bf16 v[56:59], v[232:235], v[156:159], v[56:59]
    s_add_u32 s32, s44, 6144
    buffer_load_dwordx4 v[156:159], v104, s[16:19], s32 offen
    v_mfma_f32_16x16x32_bf16 v[12:15], v[220:223], v[160:163], v[12:15]
    v_mfma_f32_16x16x32_bf16 v[28:31], v[224:227], v[160:163], v[28:31]
    v_mfma_f32_16x16x32_bf16 v[44:47], v[228:231], v[160:163], v[44:47]
    v_mfma_f32_16x16x32_bf16 v[60:63], v[232:235], v[160:163], v[60:63]
    s_add_u32 s32, s44, 63616
    buffer_load_dwordx4 v[160:163], v104, s[16:19], s32 offen
    v_mfma_f32_16x16x32_bf16 v[16:19], v[220:223], v[164:167], v[16:19]
    v_mfma_f32_16x16x32_bf16 v[32:35], v[224:227], v[164:167], v[32:35]
    v_mfma_f32_16x16x32_bf16 v[48:51], v[228:231], v[164:167], v[48:51]
    v_mfma_f32_16x16x32_bf16 v[64:67], v[232:235], v[164:167], v[64:67]
    s_add_u32 s32, s44, 121088
    buffer_load_dwordx4 v[164:167], v104, s[16:19], s32 offen
    v_mfma_f32_16x16x32_bf16 v[20:23], v[220:223], v[168:171], v[20:23]
    v_mfma_f32_16x16x32_bf16 v[36:39], v[224:227], v[168:171], v[36:39]
    v_mfma_f32_16x16x32_bf16 v[52:55], v[228:231], v[168:171], v[52:55]
    v_mfma_f32_16x16x32_bf16 v[68:71], v[232:235], v[168:171], v[68:71]
    s_add_u32 s32, s44, 178560
    buffer_load_dwordx4 v[168:171], v104, s[16:19], s32 offen
    s_waitcnt vmcnt(12)
    s_waitcnt lgkmcnt(0)
    ds_read_b64_tr_b16 v[72:73], v105 offset:16384
    ds_read_b64_tr_b16 v[74:75], v105 offset:17408
    ds_read_b64_tr_b16 v[76:77], v106 offset:16384
    ds_read_b64_tr_b16 v[78:79], v106 offset:17408
    ds_read_b64_tr_b16 v[80:81], v107 offset:16384
    ds_read_b64_tr_b16 v[82:83], v107 offset:17408
    ds_read_b64_tr_b16 v[84:85], v108 offset:16384
    ds_read_b64_tr_b16 v[86:87], v108 offset:17408
    v_mfma_f32_16x16x32_bf16 v[8:11], v[236:239], v[172:175], v[8:11]
    v_mfma_f32_16x16x32_bf16 v[24:27], v[240:243], v[172:175], v[24:27]
    v_mfma_f32_16x16x32_bf16 v[40:43], v[244:247], v[172:175], v[40:43]
    v_mfma_f32_16x16x32_bf16 v[56:59], v[248:251], v[172:175], v[56:59]
    s_add_u32 s32, s44, 7168
    buffer_load_dwordx4 v[172:175], v104, s[16:19], s32 offen
    v_mfma_f32_16x16x32_bf16 v[12:15], v[236:239], v[176:179], v[12:15]
    v_mfma_f32_16x16x32_bf16 v[28:31], v[240:243], v[176:179], v[28:31]
    v_mfma_f32_16x16x32_bf16 v[44:47], v[244:247], v[176:179], v[44:47]
    v_mfma_f32_16x16x32_bf16 v[60:63], v[248:251], v[176:179], v[60:63]
    s_add_u32 s32, s44, 64640
    buffer_load_dwordx4 v[176:179], v104, s[16:19], s32 offen
    v_mfma_f32_16x16x32_bf16 v[16:19], v[236:239], v[180:183], v[16:19]
    v_mfma_f32_16x16x32_bf16 v[32:35], v[240:243], v[180:183], v[32:35]
    v_mfma_f32_16x16x32_bf16 v[48:51], v[244:247], v[180:183], v[48:51]
    v_mfma_f32_16x16x32_bf16 v[64:67], v[248:251], v[180:183], v[64:67]
    s_add_u32 s32, s44, 122112
    buffer_load_dwordx4 v[180:183], v104, s[16:19], s32 offen
    v_mfma_f32_16x16x32_bf16 v[20:23], v[236:239], v[184:187], v[20:23]
    v_mfma_f32_16x16x32_bf16 v[36:39], v[240:243], v[184:187], v[36:39]
    v_mfma_f32_16x16x32_bf16 v[52:55], v[244:247], v[184:187], v[52:55]
    v_mfma_f32_16x16x32_bf16 v[68:71], v[248:251], v[184:187], v[68:71]
    s_add_u32 s32, s44, 179584
    buffer_load_dwordx4 v[184:187], v104, s[16:19], s32 offen
    s_waitcnt vmcnt(12)
    s_waitcnt lgkmcnt(0)
    ds_read_b64_tr_b16 v[88:89], v105 offset:0
    ds_read_b64_tr_b16 v[90:91], v105 offset:1024
    ds_read_b64_tr_b16 v[92:93], v106 offset:0
    ds_read_b64_tr_b16 v[94:95], v106 offset:1024
    ds_read_b64_tr_b16 v[96:97], v107 offset:0
    ds_read_b64_tr_b16 v[98:99], v107 offset:1024
    ds_read_b64_tr_b16 v[100:101], v108 offset:0
    ds_read_b64_tr_b16 v[102:103], v108 offset:1024
    v_mfma_f32_16x16x32_bf16 v[8:11], v[72:75], v[124:127], v[8:11]
    v_mfma_f32_16x16x32_bf16 v[24:27], v[76:79], v[124:127], v[24:27]
    s_add_u32 m0, s43, 16384
    s_add_u32 s32, s45, 294912
    buffer_load_dwordx4 v120, s[20:23], s32 offen lds
    v_mfma_f32_16x16x32_bf16 v[40:43], v[80:83], v[124:127], v[40:43]
    v_mfma_f32_16x16x32_bf16 v[56:59], v[84:87], v[124:127], v[56:59]
    s_add_u32 s32, s44, 8192
    buffer_load_dwordx4 v[124:127], v104, s[16:19], s32 offen
    v_mfma_f32_16x16x32_bf16 v[12:15], v[72:75], v[128:131], v[12:15]
    v_mfma_f32_16x16x32_bf16 v[28:31], v[76:79], v[128:131], v[28:31]
    s_add_u32 m0, s43, 17408
    s_add_u32 s32, s45, 303104
    buffer_load_dwordx4 v120, s[20:23], s32 offen lds
    v_mfma_f32_16x16x32_bf16 v[44:47], v[80:83], v[128:131], v[44:47]
    v_mfma_f32_16x16x32_bf16 v[60:63], v[84:87], v[128:131], v[60:63]
    s_add_u32 s32, s44, 65664
    buffer_load_dwordx4 v[128:131], v104, s[16:19], s32 offen
    v_mfma_f32_16x16x32_bf16 v[16:19], v[72:75], v[132:135], v[16:19]
    v_mfma_f32_16x16x32_bf16 v[32:35], v[76:79], v[132:135], v[32:35]
    s_add_u32 m0, s43, 18432
    s_add_u32 s32, s45, 311296
    buffer_load_dwordx4 v120, s[20:23], s32 offen lds
    v_mfma_f32_16x16x32_bf16 v[48:51], v[80:83], v[132:135], v[48:51]
    v_mfma_f32_16x16x32_bf16 v[64:67], v[84:87], v[132:135], v[64:67]
    s_add_u32 s32, s44, 123136
    buffer_load_dwordx4 v[132:135], v104, s[16:19], s32 offen
    v_mfma_f32_16x16x32_bf16 v[20:23], v[72:75], v[136:139], v[20:23]
    v_mfma_f32_16x16x32_bf16 v[36:39], v[76:79], v[136:139], v[36:39]
    s_add_u32 m0, s43, 19456
    s_add_u32 s32, s45, 319488
    buffer_load_dwordx4 v120, s[20:23], s32 offen lds
    v_mfma_f32_16x16x32_bf16 v[52:55], v[80:83], v[136:139], v[52:55]
    v_mfma_f32_16x16x32_bf16 v[68:71], v[84:87], v[136:139], v[68:71]
    s_add_u32 s32, s44, 180608
    buffer_load_dwordx4 v[136:139], v104, s[16:19], s32 offen
    s_waitcnt vmcnt(16)
    s_waitcnt lgkmcnt(0)
    ds_read_b64_tr_b16 v[72:73], v105 offset:4096
    ds_read_b64_tr_b16 v[74:75], v105 offset:5120
    ds_read_b64_tr_b16 v[76:77], v106 offset:4096
    ds_read_b64_tr_b16 v[78:79], v106 offset:5120
    ds_read_b64_tr_b16 v[80:81], v107 offset:4096
    ds_read_b64_tr_b16 v[82:83], v107 offset:5120
    ds_read_b64_tr_b16 v[84:85], v108 offset:4096
    ds_read_b64_tr_b16 v[86:87], v108 offset:5120
    v_mfma_f32_16x16x32_bf16 v[8:11], v[88:91], v[140:143], v[8:11]
    v_mfma_f32_16x16x32_bf16 v[24:27], v[92:95], v[140:143], v[24:27]
    s_add_u32 m0, s43, 0
    s_add_u32 s32, s45, 327680
    buffer_load_dwordx4 v120, s[20:23], s32 offen lds
    v_mfma_f32_16x16x32_bf16 v[40:43], v[96:99], v[140:143], v[40:43]
    v_mfma_f32_16x16x32_bf16 v[56:59], v[100:103], v[140:143], v[56:59]
    s_add_u32 s32, s44, 9216
    buffer_load_dwordx4 v[140:143], v104, s[16:19], s32 offen
    v_mfma_f32_16x16x32_bf16 v[12:15], v[88:91], v[144:147], v[12:15]
    v_mfma_f32_16x16x32_bf16 v[28:31], v[92:95], v[144:147], v[28:31]
    s_add_u32 m0, s43, 1024
    s_add_u32 s32, s45, 335872
    buffer_load_dwordx4 v120, s[20:23], s32 offen lds
    v_mfma_f32_16x16x32_bf16 v[44:47], v[96:99], v[144:147], v[44:47]
    v_mfma_f32_16x16x32_bf16 v[60:63], v[100:103], v[144:147], v[60:63]
    s_add_u32 s32, s44, 66688
    buffer_load_dwordx4 v[144:147], v104, s[16:19], s32 offen
    v_mfma_f32_16x16x32_bf16 v[16:19], v[88:91], v[148:151], v[16:19]
    v_mfma_f32_16x16x32_bf16 v[32:35], v[92:95], v[148:151], v[32:35]
    s_add_u32 m0, s43, 2048
    s_add_u32 s32, s45, 344064
    buffer_load_dwordx4 v120, s[20:23], s32 offen lds
    v_mfma_f32_16x16x32_bf16 v[48:51], v[96:99], v[148:151], v[48:51]
    v_mfma_f32_16x16x32_bf16 v[64:67], v[100:103], v[148:151], v[64:67]
    s_add_u32 s32, s44, 124160
    buffer_load_dwordx4 v[148:151], v104, s[16:19], s32 offen
    v_mfma_f32_16x16x32_bf16 v[20:23], v[88:91], v[152:155], v[20:23]
    v_mfma_f32_16x16x32_bf16 v[36:39], v[92:95], v[152:155], v[36:39]
    s_add_u32 m0, s43, 3072
    s_add_u32 s32, s45, 352256
    buffer_load_dwordx4 v120, s[20:23], s32 offen lds
    v_mfma_f32_16x16x32_bf16 v[52:55], v[96:99], v[152:155], v[52:55]
    v_mfma_f32_16x16x32_bf16 v[68:71], v[100:103], v[152:155], v[68:71]
    s_add_u32 s32, s44, 181632
    buffer_load_dwordx4 v[152:155], v104, s[16:19], s32 offen
    s_waitcnt vmcnt(20)
    s_waitcnt lgkmcnt(0)
    ds_read_b64_tr_b16 v[88:89], v105 offset:8192
    ds_read_b64_tr_b16 v[90:91], v105 offset:9216
    ds_read_b64_tr_b16 v[92:93], v106 offset:8192
    ds_read_b64_tr_b16 v[94:95], v106 offset:9216
    ds_read_b64_tr_b16 v[96:97], v107 offset:8192
    ds_read_b64_tr_b16 v[98:99], v107 offset:9216
    ds_read_b64_tr_b16 v[100:101], v108 offset:8192
    ds_read_b64_tr_b16 v[102:103], v108 offset:9216
    v_mfma_f32_16x16x32_bf16 v[8:11], v[72:75], v[156:159], v[8:11]
    v_mfma_f32_16x16x32_bf16 v[24:27], v[76:79], v[156:159], v[24:27]
    s_add_u32 m0, s43, 4096
    s_add_u32 s32, s45, 360448
    buffer_load_dwordx4 v120, s[20:23], s32 offen lds
    v_mfma_f32_16x16x32_bf16 v[40:43], v[80:83], v[156:159], v[40:43]
    v_mfma_f32_16x16x32_bf16 v[56:59], v[84:87], v[156:159], v[56:59]
    s_add_u32 s32, s44, 10240
    buffer_load_dwordx4 v[156:159], v104, s[16:19], s32 offen
    v_mfma_f32_16x16x32_bf16 v[12:15], v[72:75], v[160:163], v[12:15]
    v_mfma_f32_16x16x32_bf16 v[28:31], v[76:79], v[160:163], v[28:31]
    s_add_u32 m0, s43, 5120
    s_add_u32 s32, s45, 368640
    buffer_load_dwordx4 v120, s[20:23], s32 offen lds
    v_mfma_f32_16x16x32_bf16 v[44:47], v[80:83], v[160:163], v[44:47]
    v_mfma_f32_16x16x32_bf16 v[60:63], v[84:87], v[160:163], v[60:63]
    s_add_u32 s32, s44, 67712
    buffer_load_dwordx4 v[160:163], v104, s[16:19], s32 offen
    v_mfma_f32_16x16x32_bf16 v[16:19], v[72:75], v[164:167], v[16:19]
    v_mfma_f32_16x16x32_bf16 v[32:35], v[76:79], v[164:167], v[32:35]
    s_add_u32 m0, s43, 6144
    s_add_u32 s32, s45, 376832
    buffer_load_dwordx4 v120, s[20:23], s32 offen lds
    v_mfma_f32_16x16x32_bf16 v[48:51], v[80:83], v[164:167], v[48:51]
    v_mfma_f32_16x16x32_bf16 v[64:67], v[84:87], v[164:167], v[64:67]
    s_add_u32 s32, s44, 125184
    buffer_load_dwordx4 v[164:167], v104, s[16:19], s32 offen
    v_mfma_f32_16x16x32_bf16 v[20:23], v[72:75], v[168:171], v[20:23]
    v_mfma_f32_16x16x32_bf16 v[36:39], v[76:79], v[168:171], v[36:39]
    s_add_u32 m0, s43, 7168
    s_add_u32 s32, s45, 385024
    buffer_load_dwordx4 v120, s[20:23], s32 offen lds
    v_mfma_f32_16x16x32_bf16 v[52:55], v[80:83], v[168:171], v[52:55]
    v_mfma_f32_16x16x32_bf16 v[68:71], v[84:87], v[168:171], v[68:71]
    s_add_u32 s32, s44, 182656
    buffer_load_dwordx4 v[168:171], v104, s[16:19], s32 offen
    s_waitcnt vmcnt(24)
    s_waitcnt lgkmcnt(0)
    ds_read_b64_tr_b16 v[72:73], v105 offset:12288
    ds_read_b64_tr_b16 v[74:75], v105 offset:13312
    ds_read_b64_tr_b16 v[76:77], v106 offset:12288
    ds_read_b64_tr_b16 v[78:79], v106 offset:13312
    ds_read_b64_tr_b16 v[80:81], v107 offset:12288
    ds_read_b64_tr_b16 v[82:83], v107 offset:13312
    ds_read_b64_tr_b16 v[84:85], v108 offset:12288
    ds_read_b64_tr_b16 v[86:87], v108 offset:13312
    v_mfma_f32_16x16x32_bf16 v[8:11], v[88:91], v[172:175], v[8:11]
    v_mfma_f32_16x16x32_bf16 v[24:27], v[92:95], v[172:175], v[24:27]
    s_add_u32 m0, s43, 8192
    s_add_u32 s32, s45, 393216
    buffer_load_dwordx4 v120, s[20:23], s32 offen lds
    v_mfma_f32_16x16x32_bf16 v[40:43], v[96:99], v[172:175], v[40:43]
    v_mfma_f32_16x16x32_bf16 v[56:59], v[100:103], v[172:175], v[56:59]
    s_add_u32 s32, s44, 11264
    buffer_load_dwordx4 v[172:175], v104, s[16:19], s32 offen
    v_mfma_f32_16x16x32_bf16 v[12:15], v[88:91], v[176:179], v[12:15]
    v_mfma_f32_16x16x32_bf16 v[28:31], v[92:95], v[176:179], v[28:31]
    s_add_u32 m0, s43, 9216
    s_add_u32 s32, s45, 401408
    buffer_load_dwordx4 v120, s[20:23], s32 offen lds
    v_mfma_f32_16x16x32_bf16 v[44:47], v[96:99], v[176:179], v[44:47]
    v_mfma_f32_16x16x32_bf16 v[60:63], v[100:103], v[176:179], v[60:63]
    s_add_u32 s32, s44, 68736
    buffer_load_dwordx4 v[176:179], v104, s[16:19], s32 offen
    v_mfma_f32_16x16x32_bf16 v[16:19], v[88:91], v[180:183], v[16:19]
    v_mfma_f32_16x16x32_bf16 v[32:35], v[92:95], v[180:183], v[32:35]
    s_add_u32 m0, s43, 10240
    s_add_u32 s32, s45, 409600
    buffer_load_dwordx4 v120, s[20:23], s32 offen lds
    v_mfma_f32_16x16x32_bf16 v[48:51], v[96:99], v[180:183], v[48:51]
    v_mfma_f32_16x16x32_bf16 v[64:67], v[100:103], v[180:183], v[64:67]
    s_add_u32 s32, s44, 126208
    buffer_load_dwordx4 v[180:183], v104, s[16:19], s32 offen
    v_mfma_f32_16x16x32_bf16 v[20:23], v[88:91], v[184:187], v[20:23]
    v_mfma_f32_16x16x32_bf16 v[36:39], v[92:95], v[184:187], v[36:39]
    s_add_u32 m0, s43, 11264
    s_add_u32 s32, s45, 417792
    buffer_load_dwordx4 v120, s[20:23], s32 offen lds
    v_mfma_f32_16x16x32_bf16 v[52:55], v[96:99], v[184:187], v[52:55]
    v_mfma_f32_16x16x32_bf16 v[68:71], v[100:103], v[184:187], v[68:71]
    s_add_u32 s32, s44, 183680
    buffer_load_dwordx4 v[184:187], v104, s[16:19], s32 offen
    s_waitcnt vmcnt(24)
    s_waitcnt lgkmcnt(0)
    ds_read_b64_tr_b16 v[88:89], v105 offset:16384
    ds_read_b64_tr_b16 v[90:91], v105 offset:17408
    ds_read_b64_tr_b16 v[92:93], v106 offset:16384
    ds_read_b64_tr_b16 v[94:95], v106 offset:17408
    ds_read_b64_tr_b16 v[96:97], v107 offset:16384
    ds_read_b64_tr_b16 v[98:99], v107 offset:17408
    ds_read_b64_tr_b16 v[100:101], v108 offset:16384
    ds_read_b64_tr_b16 v[102:103], v108 offset:17408
    v_mfma_f32_16x16x32_bf16 v[8:11], v[72:75], v[124:127], v[8:11]
    v_mfma_f32_16x16x32_bf16 v[24:27], v[76:79], v[124:127], v[24:27]
    s_add_u32 m0, s43, 12288
    s_add_u32 s32, s45, 425984
    buffer_load_dwordx4 v120, s[20:23], s32 offen lds
    v_mfma_f32_16x16x32_bf16 v[40:43], v[80:83], v[124:127], v[40:43]
    v_mfma_f32_16x16x32_bf16 v[56:59], v[84:87], v[124:127], v[56:59]
    s_add_u32 s32, s44, 12288
    buffer_load_dwordx4 v[124:127], v104, s[16:19], s32 offen
    v_mfma_f32_16x16x32_bf16 v[12:15], v[72:75], v[128:131], v[12:15]
    v_mfma_f32_16x16x32_bf16 v[28:31], v[76:79], v[128:131], v[28:31]
    s_add_u32 m0, s43, 13312
    s_add_u32 s32, s45, 434176
    buffer_load_dwordx4 v120, s[20:23], s32 offen lds
    v_mfma_f32_16x16x32_bf16 v[44:47], v[80:83], v[128:131], v[44:47]
    v_mfma_f32_16x16x32_bf16 v[60:63], v[84:87], v[128:131], v[60:63]
    s_add_u32 s32, s44, 69760
    buffer_load_dwordx4 v[128:131], v104, s[16:19], s32 offen
    v_mfma_f32_16x16x32_bf16 v[16:19], v[72:75], v[132:135], v[16:19]
    v_mfma_f32_16x16x32_bf16 v[32:35], v[76:79], v[132:135], v[32:35]
    s_add_u32 m0, s43, 14336
    s_add_u32 s32, s45, 442368
    buffer_load_dwordx4 v120, s[20:23], s32 offen lds
    v_mfma_f32_16x16x32_bf16 v[48:51], v[80:83], v[132:135], v[48:51]
    v_mfma_f32_16x16x32_bf16 v[64:67], v[84:87], v[132:135], v[64:67]
    s_add_u32 s32, s44, 127232
    buffer_load_dwordx4 v[132:135], v104, s[16:19], s32 offen
    v_mfma_f32_16x16x32_bf16 v[20:23], v[72:75], v[136:139], v[20:23]
    v_mfma_f32_16x16x32_bf16 v[36:39], v[76:79], v[136:139], v[36:39]
    s_add_u32 m0, s43, 15360
    s_add_u32 s32, s45, 450560
    buffer_load_dwordx4 v120, s[20:23], s32 offen lds
    v_mfma_f32_16x16x32_bf16 v[52:55], v[80:83], v[136:139], v[52:55]
    v_mfma_f32_16x16x32_bf16 v[68:71], v[84:87], v[136:139], v[68:71]
    s_add_u32 s32, s44, 184704
    buffer_load_dwordx4 v[136:139], v104, s[16:19], s32 offen
    s_waitcnt vmcnt(24)
    s_waitcnt lgkmcnt(0)
    ds_read_b64_tr_b16 v[72:73], v105 offset:0
    ds_read_b64_tr_b16 v[74:75], v105 offset:1024
    ds_read_b64_tr_b16 v[76:77], v106 offset:0
    ds_read_b64_tr_b16 v[78:79], v106 offset:1024
    ds_read_b64_tr_b16 v[80:81], v107 offset:0
    ds_read_b64_tr_b16 v[82:83], v107 offset:1024
    ds_read_b64_tr_b16 v[84:85], v108 offset:0
    ds_read_b64_tr_b16 v[86:87], v108 offset:1024
    v_mfma_f32_16x16x32_bf16 v[8:11], v[88:91], v[140:143], v[8:11]
    v_mfma_f32_16x16x32_bf16 v[24:27], v[92:95], v[140:143], v[24:27]
    v_mfma_f32_16x16x32_bf16 v[40:43], v[96:99], v[140:143], v[40:43]
    v_mfma_f32_16x16x32_bf16 v[56:59], v[100:103], v[140:143], v[56:59]
    s_add_u32 s32, s44, 13312
    buffer_load_dwordx4 v[140:143], v104, s[16:19], s32 offen
    v_mfma_f32_16x16x32_bf16 v[12:15], v[88:91], v[144:147], v[12:15]
    v_mfma_f32_16x16x32_bf16 v[28:31], v[92:95], v[144:147], v[28:31]
    v_mfma_f32_16x16x32_bf16 v[44:47], v[96:99], v[144:147], v[44:47]
    v_mfma_f32_16x16x32_bf16 v[60:63], v[100:103], v[144:147], v[60:63]
    s_add_u32 s32, s44, 70784
    buffer_load_dwordx4 v[144:147], v104, s[16:19], s32 offen
    v_mfma_f32_16x16x32_bf16 v[16:19], v[88:91], v[148:151], v[16:19]
    v_mfma_f32_16x16x32_bf16 v[32:35], v[92:95], v[148:151], v[32:35]
    v_mfma_f32_16x16x32_bf16 v[48:51], v[96:99], v[148:151], v[48:51]
    v_mfma_f32_16x16x32_bf16 v[64:67], v[100:103], v[148:151], v[64:67]
    s_add_u32 s32, s44, 128256
    buffer_load_dwordx4 v[148:151], v104, s[16:19], s32 offen
    v_mfma_f32_16x16x32_bf16 v[20:23], v[88:91], v[152:155], v[20:23]
    v_mfma_f32_16x16x32_bf16 v[36:39], v[92:95], v[152:155], v[36:39]
    v_mfma_f32_16x16x32_bf16 v[52:55], v[96:99], v[152:155], v[52:55]
    v_mfma_f32_16x16x32_bf16 v[68:71], v[100:103], v[152:155], v[68:71]
    s_add_u32 s32, s44, 185728
    buffer_load_dwordx4 v[152:155], v104, s[16:19], s32 offen
    s_waitcnt vmcnt(20)
    s_waitcnt lgkmcnt(0)
    s_lshl_b32 s32, s30, 9
    s_add_u32 s32, s32, 2162688
    buffer_load_dwordx2 v[188:189], v115, s[16:19], s32 offen offset:0 sc1
    buffer_load_dwordx2 v[190:191], v115, s[16:19], s32 offen offset:128 sc1
    buffer_load_dwordx2 v[192:193], v115, s[16:19], s32 offen offset:256 sc1
    buffer_load_dwordx2 v[194:195], v115, s[16:19], s32 offen offset:384 sc1
    s_add_u32 s32, s35, 0
    buffer_load_dwordx2 v[196:197], v113, s[12:15], s32 offen
    s_add_u32 s32, s35, 16384
    buffer_load_dwordx2 v[198:199], v113, s[12:15], s32 offen
    s_add_u32 s32, s35, 32768
    buffer_load_dwordx2 v[200:201], v113, s[12:15], s32 offen
    s_add_u32 s32, s35, 49152
    buffer_load_dwordx2 v[202:203], v113, s[12:15], s32 offen
    ds_read_b64_tr_b16 v[88:89], v105 offset:4096
    ds_read_b64_tr_b16 v[90:91], v105 offset:5120
    ds_read_b64_tr_b16 v[92:93], v106 offset:4096
    ds_read_b64_tr_b16 v[94:95], v106 offset:5120
    ds_read_b64_tr_b16 v[96:97], v107 offset:4096
    ds_read_b64_tr_b16 v[98:99], v107 offset:5120
    ds_read_b64_tr_b16 v[100:101], v108 offset:4096
    ds_read_b64_tr_b16 v[102:103], v108 offset:5120
    v_mfma_f32_16x16x32_bf16 v[8:11], v[72:75], v[156:159], v[8:11]
    v_mfma_f32_16x16x32_bf16 v[24:27], v[76:79], v[156:159], v[24:27]
    v_mfma_f32_16x16x32_bf16 v[40:43], v[80:83], v[156:159], v[40:43]
    v_mfma_f32_16x16x32_bf16 v[56:59], v[84:87], v[156:159], v[56:59]
    v_mfma_f32_16x16x32_bf16 v[12:15], v[72:75], v[160:163], v[12:15]
    v_mfma_f32_16x16x32_bf16 v[28:31], v[76:79], v[160:163], v[28:31]
    v_mfma_f32_16x16x32_bf16 v[44:47], v[80:83], v[160:163], v[44:47]
    v_mfma_f32_16x16x32_bf16 v[60:63], v[84:87], v[160:163], v[60:63]
    v_mfma_f32_16x16x32_bf16 v[16:19], v[72:75], v[164:167], v[16:19]
    v_mfma_f32_16x16x32_bf16 v[32:35], v[76:79], v[164:167], v[32:35]
    v_mfma_f32_16x16x32_bf16 v[48:51], v[80:83], v[164:167], v[48:51]
    v_mfma_f32_16x16x32_bf16 v[64:67], v[84:87], v[164:167], v[64:67]
    v_mfma_f32_16x16x32_bf16 v[20:23], v[72:75], v[168:171], v[20:23]
    v_mfma_f32_16x16x32_bf16 v[36:39], v[76:79], v[168:171], v[36:39]
    v_mfma_f32_16x16x32_bf16 v[52:55], v[80:83], v[168:171], v[52:55]
    v_mfma_f32_16x16x32_bf16 v[68:71], v[84:87], v[168:171], v[68:71]
    s_waitcnt vmcnt(20)
    s_waitcnt lgkmcnt(0)
    s_lshl_b32 s32, s31, 9
    s_add_u32 s32, s32, 13713408
    s_mov_b64 exec, 0xffffffff
    buffer_load_dword v212, v110, s[16:19], s32 offen sc1
    s_mov_b64 exec, -1
    ds_read_b64_tr_b16 v[72:73], v105 offset:8192
    ds_read_b64_tr_b16 v[74:75], v105 offset:9216
    ds_read_b64_tr_b16 v[76:77], v106 offset:8192
    ds_read_b64_tr_b16 v[78:79], v106 offset:9216
    ds_read_b64_tr_b16 v[80:81], v107 offset:8192
    ds_read_b64_tr_b16 v[82:83], v107 offset:9216
    ds_read_b64_tr_b16 v[84:85], v108 offset:8192
    ds_read_b64_tr_b16 v[86:87], v108 offset:9216
    v_mfma_f32_16x16x32_bf16 v[8:11], v[88:91], v[172:175], v[8:11]
    v_mfma_f32_16x16x32_bf16 v[24:27], v[92:95], v[172:175], v[24:27]
    v_mfma_f32_16x16x32_bf16 v[40:43], v[96:99], v[172:175], v[40:43]
    v_mfma_f32_16x16x32_bf16 v[56:59], v[100:103], v[172:175], v[56:59]
    v_mfma_f32_16x16x32_bf16 v[12:15], v[88:91], v[176:179], v[12:15]
    v_mfma_f32_16x16x32_bf16 v[28:31], v[92:95], v[176:179], v[28:31]
    v_mfma_f32_16x16x32_bf16 v[44:47], v[96:99], v[176:179], v[44:47]
    v_mfma_f32_16x16x32_bf16 v[60:63], v[100:103], v[176:179], v[60:63]
    v_mfma_f32_16x16x32_bf16 v[16:19], v[88:91], v[180:183], v[16:19]
    v_mfma_f32_16x16x32_bf16 v[32:35], v[92:95], v[180:183], v[32:35]
    v_mfma_f32_16x16x32_bf16 v[48:51], v[96:99], v[180:183], v[48:51]
    v_mfma_f32_16x16x32_bf16 v[64:67], v[100:103], v[180:183], v[64:67]
    v_mfma_f32_16x16x32_bf16 v[20:23], v[88:91], v[184:187], v[20:23]
    v_mfma_f32_16x16x32_bf16 v[36:39], v[92:95], v[184:187], v[36:39]
    v_mfma_f32_16x16x32_bf16 v[52:55], v[96:99], v[184:187], v[52:55]
    v_mfma_f32_16x16x32_bf16 v[68:71], v[100:103], v[184:187], v[68:71]
    s_waitcnt vmcnt(13)
    s_waitcnt lgkmcnt(0)
    ds_read_b64_tr_b16 v[88:89], v105 offset:12288
    ds_read_b64_tr_b16 v[90:91], v105 offset:13312
    ds_read_b64_tr_b16 v[92:93], v106 offset:12288
    ds_read_b64_tr_b16 v[94:95], v106 offset:13312
    ds_read_b64_tr_b16 v[96:97], v107 offset:12288
    ds_read_b64_tr_b16 v[98:99], v107 offset:13312
    ds_read_b64_tr_b16 v[100:101], v108 offset:12288
    ds_read_b64_tr_b16 v[102:103], v108 offset:13312
    v_mfma_f32_16x16x32_bf16 v[8:11], v[72:75], v[124:127], v[8:11]
    v_mfma_f32_16x16x32_bf16 v[24:27], v[76:79], v[124:127], v[24:27]
    v_mfma_f32_16x16x32_bf16 v[40:43], v[80:83], v[124:127], v[40:43]
    v_mfma_f32_16x16x32_bf16 v[56:59], v[84:87], v[124:127], v[56:59]
    v_mfma_f32_16x16x32_bf16 v[12:15], v[72:75], v[128:131], v[12:15]
    v_mfma_f32_16x16x32_bf16 v[28:31], v[76:79], v[128:131], v[28:31]
    v_mfma_f32_16x16x32_bf16 v[44:47], v[80:83], v[128:131], v[44:47]
    v_mfma_f32_16x16x32_bf16 v[60:63], v[84:87], v[128:131], v[60:63]
    v_mfma_f32_16x16x32_bf16 v[16:19], v[72:75], v[132:135], v[16:19]
    v_mfma_f32_16x16x32_bf16 v[32:35], v[76:79], v[132:135], v[32:35]
    v_mfma_f32_16x16x32_bf16 v[48:51], v[80:83], v[132:135], v[48:51]
    v_mfma_f32_16x16x32_bf16 v[64:67], v[84:87], v[132:135], v[64:67]
    v_mfma_f32_16x16x32_bf16 v[20:23], v[72:75], v[136:139], v[20:23]
    v_mfma_f32_16x16x32_bf16 v[36:39], v[76:79], v[136:139], v[36:39]
    v_mfma_f32_16x16x32_bf16 v[52:55], v[80:83], v[136:139], v[52:55]
    v_mfma_f32_16x16x32_bf16 v[68:71], v[84:87], v[136:139], v[68:71]
    s_waitcnt vmcnt(9)
    s_waitcnt lgkmcnt(0)
    v_mfma_f32_16x16x32_bf16 v[8:11], v[88:91], v[140:143], v[8:11]
    v_mfma_f32_16x16x32_bf16 v[24:27], v[92:95], v[140:143], v[24:27]
    v_mfma_f32_16x16x32_bf16 v[40:43], v[96:99], v[140:143], v[40:43]
    v_mfma_f32_16x16x32_bf16 v[56:59], v[100:103], v[140:143], v[56:59]
    v_mfma_f32_16x16x32_bf16 v[12:15], v[88:91], v[144:147], v[12:15]
    v_mfma_f32_16x16x32_bf16 v[28:31], v[92:95], v[144:147], v[28:31]
    v_mfma_f32_16x16x32_bf16 v[44:47], v[96:99], v[144:147], v[44:47]
    v_mfma_f32_16x16x32_bf16 v[60:63], v[100:103], v[144:147], v[60:63]
    v_mfma_f32_16x16x32_bf16 v[16:19], v[88:91], v[148:151], v[16:19]
    v_mfma_f32_16x16x32_bf16 v[32:35], v[92:95], v[148:151], v[32:35]
    v_mfma_f32_16x16x32_bf16 v[48:51], v[96:99], v[148:151], v[48:51]
    v_mfma_f32_16x16x32_bf16 v[64:67], v[100:103], v[148:151], v[64:67]
    v_mfma_f32_16x16x32_bf16 v[20:23], v[88:91], v[152:155], v[20:23]
    v_mfma_f32_16x16x32_bf16 v[36:39], v[92:95], v[152:155], v[36:39]
    v_mfma_f32_16x16x32_bf16 v[52:55], v[96:99], v[152:155], v[52:55]
    v_mfma_f32_16x16x32_bf16 v[68:71], v[100:103], v[152:155], v[68:71]
    s_waitcnt vmcnt(0)
    s_mov_b64 exec, 0xffffffff
    v_cmp_ne_u32 vcc, s37, v212
    s_mov_b64 exec, -1
    s_nop 4
    s_cbranch_vccz F_PC2_12
    s_lshl_b32 s32, s31, 9
    s_add_u32 s32, s32, 13713408
    s_mov_b32 s33, 0
    s_mov_b64 exec, 0xffffffff
POLL_13:
    buffer_load_dword v116, v110, s[16:19], s32 offen sc1
    s_waitcnt vmcnt(0)
    v_cmp_ne_u32 vcc, s37, v116
    s_nop 4
    s_cbranch_vccz POLLD_14
    s_sleep 2
    s_add_u32 s33, s33, 1
    s_cmp_lt_u32 s33, 65536
    s_cbranch_scc1 POLL_13
POLLD_14:
    s_mov_b64 exec, -1
F_PC2_12:
    s_lshl_b32 s32, s31, 6
    s_lshl_b32 s33, s3, 4
    s_add_u32 s32, s32, s33
    s_lshl_b32 s32, s32, 12
    s_lshl_b32 s33, s30, 7
    s_add_u32 s32, s32, s33
    s_add_u32 s32, s32, 11534336
    buffer_load_dwordx4 v[204:207], v114, s[16:19], s32 offen sc1
    buffer_load_dwordx4 v[208:211], v114, s[16:19], s32 offen offset:16 sc1
    v_lshlrev_b32 v4, 4, v1
    v_add_u32 v3, s43, v4
    s_add_u32 s32, s3, 1
    s_and_b32 s32, s32, 3
    s_cmp_eq_u32 s32, 0
    s_cbranch_scc0 F_WN_16
    ds_write_b128 v3, v[8:11] offset:0
    ds_write_b128 v3, v[12:15] offset:1024
    ds_write_b128 v3, v[16:19] offset:2048
    ds_write_b128 v3, v[20:23] offset:3072
    s_branch F_W_15
F_WN_16:
    s_cmp_eq_u32 s32, 1
    s_cbranch_scc0 F_WN_17
    ds_write_b128 v3, v[24:27] offset:0
    ds_write_b128 v3, v[28:31] offset:1024
    ds_write_b128 v3, v[32:35] offset:2048
    ds_write_b128 v3, v[36:39] offset:3072
    s_branch F_W_15
F_WN_17:
    s_cmp_eq_u32 s32, 2
    s_cbranch_scc0 F_WN_18
    ds_write_b128 v3, v[40:43] offset:0
    ds_write_b128 v3, v[44:47] offset:1024
    ds_write_b128 v3, v[48:51] offset:2048
    ds_write_b128 v3, v[52:55] offset:3072
    s_branch F_W_15
F_WN_18:
    s_cmp_eq_u32 s32, 3
    s_cbranch_scc0 F_WN_19
    ds_write_b128 v3, v[56:59] offset:0
    ds_write_b128 v3, v[60:63] offset:1024
    ds_write_b128 v3, v[64:67] offset:2048
    ds_write_b128 v3, v[68:71] offset:3072
    s_branch F_W_15
F_WN_19:
F_W_15:
    s_add_u32 s32, s3, 2
    s_and_b32 s32, s32, 3
    s_cmp_eq_u32 s32, 0
    s_cbranch_scc0 F_WN_21
    ds_write_b128 v3, v[8:11] offset:4096
    ds_write_b128 v3, v[12:15] offset:5120
    ds_write_b128 v3, v[16:19] offset:6144
    ds_write_b128 v3, v[20:23] offset:7168
    s_branch F_W_20
F_WN_21:
    s_cmp_eq_u32 s32, 1
    s_cbranch_scc0 F_WN_22
    ds_write_b128 v3, v[24:27] offset:4096
    ds_write_b128 v3, v[28:31] offset:5120
    ds_write_b128 v3, v[32:35] offset:6144
    ds_write_b128 v3, v[36:39] offset:7168
    s_branch F_W_20
F_WN_22:
    s_cmp_eq_u32 s32, 2
    s_cbranch_scc0 F_WN_23
    ds_write_b128 v3, v[40:43] offset:4096
    ds_write_b128 v3, v[44:47] offset:5120
    ds_write_b128 v3, v[48:51] offset:6144
    ds_write_b128 v3, v[52:55] offset:7168
    s_branch F_W_20
F_WN_23:
    s_cmp_eq_u32 s32, 3
    s_cbranch_scc0 F_WN_24
    ds_write_b128 v3, v[56:59] offset:4096
    ds_write_b128 v3, v[60:63] offset:5120
    ds_write_b128 v3, v[64:67] offset:6144
    ds_write_b128 v3, v[68:71] offset:7168
    s_branch F_W_20
F_WN_24:
F_W_20:
    s_add_u32 s32, s3, 3
    s_and_b32 s32, s32, 3
    s_cmp_eq_u32 s32, 0
    s_cbranch_scc0 F_WN_26
    ds_write_b128 v3, v[8:11] offset:8192
    ds_write_b128 v3, v[12:15] offset:9216
    ds_write_b128 v3, v[16:19] offset:10240
    ds_write_b128 v3, v[20:23] offset:11264
    s_branch F_W_25
F_WN_26:
    s_cmp_eq_u32 s32, 1
    s_cbranch_scc0 F_WN_27
    ds_write_b128 v3, v[24:27] offset:8192
    ds_write_b128 v3, v[28:31] offset:9216
    ds_write_b128 v3, v[32:35] offset:10240
    ds_write_b128 v3, v[36:39] offset:11264
    s_branch F_W_25
F_WN_27:
    s_cmp_eq_u32 s32, 2
    s_cbranch_scc0 F_WN_28
    ds_write_b128 v3, v[40:43] offset:8192
    ds_write_b128 v3, v[44:47] offset:9216
    ds_write_b128 v3, v[48:51] offset:10240
    ds_write_b128 v3, v[52:55] offset:11264
    s_branch F_W_25
F_WN_28:
    s_cmp_eq_u32 s32, 3
    s_cbranch_scc0 F_WN_29
    ds_write_b128 v3, v[56:59] offset:8192
    ds_write_b128 v3, v[60:63] offset:9216
    ds_write_b128 v3, v[64:67] offset:10240
    ds_write_b128 v3, v[68:71] offset:11264
    s_branch F_W_25
F_WN_29:
F_W_25:
    s_cmp_eq_u32 s3, 0
    s_cbranch_scc0 F_MN_31
    v_mov_b32 v172, v8
    v_mov_b32 v173, v9
    v_mov_b32 v174, v10
    v_mov_b32 v175, v11
    v_mov_b32 v176, v12
    v_mov_b32 v177, v13
    v_mov_b32 v178, v14
    v_mov_b32 v179, v15
    v_mov_b32 v180, v16
    v_mov_b32 v181, v17
    v_mov_b32 v182, v18
    v_mov_b32 v183, v19
    v_mov_b32 v184, v20
    v_mov_b32 v185, v21
    v_mov_b32 v186, v22
    v_mov_b32 v187, v23
    s_branch F_M_30
F_MN_31:
    s_cmp_eq_u32 s3, 1
    s_cbranch_scc0 F_MN_32
    v_mov_b32 v172, v24
    v_mov_b32 v173, v25
    v_mov_b32 v174, v26
    v_mov_b32 v175, v27
    v_mov_b32 v176, v28
    v_mov_b32 v177, v29
    v_mov_b32 v178, v30
    v_mov_b32 v179, v31
    v_mov_b32 v180, v32
    v_mov_b32 v181, v33
    v_mov_b32 v182, v34
    v_mov_b32 v183, v35
    v_mov_b32 v184, v36
    v_mov_b32 v185, v37
    v_mov_b32 v186, v38
    v_mov_b32 v187, v39
    s_branch F_M_30
F_MN_32:
    s_cmp_eq_u32 s3, 2
    s_cbranch_scc0 F_MN_33
    v_mov_b32 v172, v40
    v_mov_b32 v173, v41
    v_mov_b32 v174, v42
    v_mov_b32 v175, v43
    v_mov_b32 v176, v44
    v_mov_b32 v177, v45
    v_mov_b32 v178, v46
    v_mov_b32 v179, v47
    v_mov_b32 v180, v48
    v_mov_b32 v181, v49
    v_mov_b32 v182, v50
    v_mov_b32 v183, v51
    v_mov_b32 v184, v52
    v_mov_b32 v185, v53
    v_mov_b32 v186, v54
    v_mov_b32 v187, v55
    s_branch F_M_30
F_MN_33:
    s_cmp_eq_u32 s3, 3
    s_cbranch_scc0 F_MN_34
    v_mov_b32 v172, v56
    v_mov_b32 v173, v57
    v_mov_b32 v174, v58
    v_mov_b32 v175, v59
    v_mov_b32 v176, v60
    v_mov_b32 v177, v61
    v_mov_b32 v178, v62
    v_mov_b32 v179, v63
    v_mov_b32 v180, v64
    v_mov_b32 v181, v65
    v_mov_b32 v182, v66
    v_mov_b32 v183, v67
    v_mov_b32 v184, v68
    v_mov_b32 v185, v69
    v_mov_b32 v186, v70
    v_mov_b32 v187, v71
    s_branch F_M_30
F_MN_34:
F_M_30:
    s_waitcnt lgkmcnt(0)
    v_mov_b32 v6, 1
    s_mov_b64 exec, 1
    ds_add_u32 v5, v6 offset:40
    s_mov_b64 exec, -1
GS_35:
    ds_read_b32 v6, v5 offset:40
    s_waitcnt lgkmcnt(0)
    v_readfirstlane_b32 s46, v6
    s_nop 0
    s_cmp_lt_u32 s46, 4
    s_cbranch_scc1 GS_35
    s_sub_u32 s32, s3, 1
    s_and_b32 s32, s32, 3
    s_and_b32 s33, s32, 1
    s_mul_i32 s33, s33, 20480
    s_cmp_lt_u32 s32, 2
    s_cselect_b32 s32, 94336, 0
    s_add_u32 s32, s32, s33
    v_add_u32 v3, s32, v4
    ds_read_b128 v[124:127], v3 offset:0
    ds_read_b128 v[128:131], v3 offset:1024
    ds_read_b128 v[132:135], v3 offset:2048
    ds_read_b128 v[136:139], v3 offset:3072
    s_sub_u32 s32, s3, 2
    s_and_b32 s32, s32, 3
    s_and_b32 s33, s32, 1
    s_mul_i32 s33, s33, 20480
    s_cmp_lt_u32 s32, 2
    s_cselect_b32 s32, 94336, 0
    s_add_u32 s32, s32, s33
    v_add_u32 v3, s32, v4
    ds_read_b128 v[140:143], v3 offset:4096
    ds_read_b128 v[144:147], v3 offset:5120
    ds_read_b128 v[148:151], v3 offset:6144
    ds_read_b128 v[152:155], v3 offset:7168
    s_sub_u32 s32, s3, 3
    s_and_b32 s32, s32, 3
    s_and_b32 s33, s32, 1
    s_mul_i32 s33, s33, 20480
    s_cmp_lt_u32 s32, 2
    s_cselect_b32 s32, 94336, 0
    s_add_u32 s32, s32, s33
    v_add_u32 v3, s32, v4
    ds_read_b128 v[156:159], v3 offset:8192
    ds_read_b128 v[160:163], v3 offset:9216
    ds_read_b128 v[164:167], v3 offset:10240
    ds_read_b128 v[168:171], v3 offset:11264
    s_waitcnt vmcnt(0)
    v_lshrrev_b32 v2, 2, v1
    v_lshlrev_b32 v2, 7, v2
    v_and_b32 v3, 3, v1
    v_lshl_add_u32 v2, v3, 5, v2
    v_add_u32 v2, s43, v2
    ds_write_b128 v2, v[204:207] offset:12288
    ds_write_b128 v2, v[208:211] offset:12304
    v_lshlrev_b32 v2, 2, v112
    v_bfe_u32 v4, v1, 2, 2
    v_add_u32 v2, v2, v4
    v_lshlrev_b32 v2, 7, v2
    v_and_b32 v4, 3, v1
    v_lshl_add_u32 v2, v4, 3, v2
    v_add_u32 v2, s43, v2
    s_waitcnt lgkmcnt(0)
    ds_read_b64_tr_b16 v[204:205], v2 offset:12288
    ds_read_b64_tr_b16 v[206:207], v2 offset:12320
    ds_read_b64_tr_b16 v[208:209], v2 offset:12352
    ds_read_b64_tr_b16 v[210:211], v2 offset:12384
    v_add_f32 v172, v172, v124
    v_add_f32 v173, v173, v125
    v_add_f32 v174, v174, v126
    v_add_f32 v175, v175, v127
    v_add_f32 v176, v176, v128
    v_add_f32 v177, v177, v129
    v_add_f32 v178, v178, v130
    v_add_f32 v179, v179, v131
    v_add_f32 v180, v180, v132
    v_add_f32 v181, v181, v133
    v_add_f32 v182, v182, v134
    v_add_f32 v183, v183, v135
    v_add_f32 v184, v184, v136
    v_add_f32 v185, v185, v137
    v_add_f32 v186, v186, v138
    v_add_f32 v187, v187, v139
    v_add_f32 v172, v172, v140
    v_add_f32 v173, v173, v141
    v_add_f32 v174, v174, v142
    v_add_f32 v175, v175, v143
    v_add_f32 v176, v176, v144
    v_add_f32 v177, v177, v145
    v_add_f32 v178, v178, v146
    v_add_f32 v179, v179, v147
    v_add_f32 v180, v180, v148
    v_add_f32 v181, v181, v149
    v_add_f32 v182, v182, v150
    v_add_f32 v183, v183, v151
    v_add_f32 v184, v184, v152
    v_add_f32 v185, v185, v153
    v_add_f32 v186, v186, v154
    v_add_f32 v187, v187, v155
    v_add_f32 v172, v172, v156
    v_add_f32 v173, v173, v157
    v_add_f32 v174, v174, v158
    v_add_f32 v175, v175, v159
    v_add_f32 v176, v176, v160
    v_add_f32 v177, v177, v161
    v_add_f32 v178, v178, v162
    v_add_f32 v179, v179, v163
    v_add_f32 v180, v180, v164
    v_add_f32 v181, v181, v165
    v_add_f32 v182, v182, v166
    v_add_f32 v183, v183, v167
    v_add_f32 v184, v184, v168
    v_add_f32 v185, v185, v169
    v_add_f32 v186, v186, v170
    v_add_f32 v187, v187, v171
    s_waitcnt lgkmcnt(0)
    v_mul_f32 v72, v189, v189
    v_mul_f32 v172, v172, v72
    v_mul_f32 v173, v173, v72
    v_mul_f32 v174, v174, v72
    v_mul_f32 v175, v175, v72
    v_cvt_pk_bf16_f32 v72, v172, v173
    v_cvt_pk_bf16_f32 v73, v174, v175
    v_lshlrev_b32 v172, 16, v72
    v_and_b32 v173, s36, v72
    v_lshlrev_b32 v174, 16, v73
    v_and_b32 v175, s36, v73
    v_mul_f32 v74, 0xbfb8aa3b, v172
    v_mul_f32 v75, 0xbfb8aa3b, v173
    v_mul_f32 v76, 0xbfb8aa3b, v174
    v_mul_f32 v77, 0xbfb8aa3b, v175
    v_exp_f32 v74, v74
    v_exp_f32 v75, v75
    v_exp_f32 v76, v76
    v_exp_f32 v77, v77
    v_add_f32 v74, 1.0, v74
    v_add_f32 v75, 1.0, v75
    v_add_f32 v76, 1.0, v76
    v_add_f32 v77, 1.0, v77
    v_rcp_f32 v74, v74
    v_rcp_f32 v75, v75
    v_rcp_f32 v76, v76
    v_rcp_f32 v77, v77
    v_mul_f32 v172, v172, v74
    v_mul_f32 v173, v173, v75
    v_mul_f32 v174, v174, v76
    v_mul_f32 v175, v175, v77
    v_cvt_pk_bf16_f32 v72, v172, v173
    v_cvt_pk_bf16_f32 v73, v174, v175
    v_lshlrev_b32 v172, 16, v72
    v_and_b32 v173, s36, v72
    v_lshlrev_b32 v74, 16, v204
    v_and_b32 v75, s36, v204
    v_lshlrev_b32 v174, 16, v73
    v_and_b32 v175, s36, v73
    v_lshlrev_b32 v76, 16, v205
    v_and_b32 v77, s36, v205
    v_mul_f32 v172, v172, v74
    v_mul_f32 v173, v173, v75
    v_mul_f32 v174, v174, v76
    v_mul_f32 v175, v175, v77
    v_cvt_pk_bf16_f32 v72, v172, v173
    v_cvt_pk_bf16_f32 v73, v174, v175
    v_lshlrev_b32 v172, 16, v72
    v_and_b32 v173, s36, v72
    v_lshlrev_b32 v74, 16, v196
    v_and_b32 v75, s36, v196
    v_lshlrev_b32 v174, 16, v73
    v_and_b32 v175, s36, v73
    v_lshlrev_b32 v76, 16, v197
    v_and_b32 v77, s36, v197
    v_add_f32 v172, v172, v74
    v_add_f32 v173, v173, v75
    v_add_f32 v174, v174, v76
    v_add_f32 v175, v175, v77
    v_cvt_pk_bf16_f32 v124, v172, v173
    v_cvt_pk_bf16_f32 v125, v174, v175
    s_add_u32 s32, s35, 0
    buffer_store_dwordx2 v[124:125], v113, s[24:27], s32 offen
    v_mul_f32 v72, v191, v191
    v_mul_f32 v176, v176, v72
    v_mul_f32 v177, v177, v72
    v_mul_f32 v178, v178, v72
    v_mul_f32 v179, v179, v72
    v_cvt_pk_bf16_f32 v72, v176, v177
    v_cvt_pk_bf16_f32 v73, v178, v179
    v_lshlrev_b32 v176, 16, v72
    v_and_b32 v177, s36, v72
    v_lshlrev_b32 v178, 16, v73
    v_and_b32 v179, s36, v73
    v_mul_f32 v74, 0xbfb8aa3b, v176
    v_mul_f32 v75, 0xbfb8aa3b, v177
    v_mul_f32 v76, 0xbfb8aa3b, v178
    v_mul_f32 v77, 0xbfb8aa3b, v179
    v_exp_f32 v74, v74
    v_exp_f32 v75, v75
    v_exp_f32 v76, v76
    v_exp_f32 v77, v77
    v_add_f32 v74, 1.0, v74
    v_add_f32 v75, 1.0, v75
    v_add_f32 v76, 1.0, v76
    v_add_f32 v77, 1.0, v77
    v_rcp_f32 v74, v74
    v_rcp_f32 v75, v75
    v_rcp_f32 v76, v76
    v_rcp_f32 v77, v77
    v_mul_f32 v176, v176, v74
    v_mul_f32 v177, v177, v75
    v_mul_f32 v178, v178, v76
    v_mul_f32 v179, v179, v77
    v_cvt_pk_bf16_f32 v72, v176, v177
    v_cvt_pk_bf16_f32 v73, v178, v179
    v_lshlrev_b32 v176, 16, v72
    v_and_b32 v177, s36, v72
    v_lshlrev_b32 v74, 16, v206
    v_and_b32 v75, s36, v206
    v_lshlrev_b32 v178, 16, v73
    v_and_b32 v179, s36, v73
    v_lshlrev_b32 v76, 16, v207
    v_and_b32 v77, s36, v207
    v_mul_f32 v176, v176, v74
    v_mul_f32 v177, v177, v75
    v_mul_f32 v178, v178, v76
    v_mul_f32 v179, v179, v77
    v_cvt_pk_bf16_f32 v72, v176, v177
    v_cvt_pk_bf16_f32 v73, v178, v179
    v_lshlrev_b32 v176, 16, v72
    v_and_b32 v177, s36, v72
    v_lshlrev_b32 v74, 16, v198
    v_and_b32 v75, s36, v198
    v_lshlrev_b32 v178, 16, v73
    v_and_b32 v179, s36, v73
    v_lshlrev_b32 v76, 16, v199
    v_and_b32 v77, s36, v199
    v_add_f32 v176, v176, v74
    v_add_f32 v177, v177, v75
    v_add_f32 v178, v178, v76
    v_add_f32 v179, v179, v77
    v_cvt_pk_bf16_f32 v126, v176, v177
    v_cvt_pk_bf16_f32 v127, v178, v179
    s_add_u32 s32, s35, 16384
    buffer_store_dwordx2 v[126:127], v113, s[24:27], s32 offen
    v_mul_f32 v72, v193, v193
    v_mul_f32 v180, v180, v72
    v_mul_f32 v181, v181, v72
    v_mul_f32 v182, v182, v72
    v_mul_f32 v183, v183, v72
    v_cvt_pk_bf16_f32 v72, v180, v181
    v_cvt_pk_bf16_f32 v73, v182, v183
    v_lshlrev_b32 v180, 16, v72
    v_and_b32 v181, s36, v72
    v_lshlrev_b32 v182, 16, v73
    v_and_b32 v183, s36, v73
    v_mul_f32 v74, 0xbfb8aa3b, v180
    v_mul_f32 v75, 0xbfb8aa3b, v181
    v_mul_f32 v76, 0xbfb8aa3b, v182
    v_mul_f32 v77, 0xbfb8aa3b, v183
    v_exp_f32 v74, v74
    v_exp_f32 v75, v75
    v_exp_f32 v76, v76
    v_exp_f32 v77, v77
    v_add_f32 v74, 1.0, v74
    v_add_f32 v75, 1.0, v75
    v_add_f32 v76, 1.0, v76
    v_add_f32 v77, 1.0, v77
    v_rcp_f32 v74, v74
    v_rcp_f32 v75, v75
    v_rcp_f32 v76, v76
    v_rcp_f32 v77, v77
    v_mul_f32 v180, v180, v74
    v_mul_f32 v181, v181, v75
    v_mul_f32 v182, v182, v76
    v_mul_f32 v183, v183, v77
    v_cvt_pk_bf16_f32 v72, v180, v181
    v_cvt_pk_bf16_f32 v73, v182, v183
    v_lshlrev_b32 v180, 16, v72
    v_and_b32 v181, s36, v72
    v_lshlrev_b32 v74, 16, v208
    v_and_b32 v75, s36, v208
    v_lshlrev_b32 v182, 16, v73
    v_and_b32 v183, s36, v73
    v_lshlrev_b32 v76, 16, v209
    v_and_b32 v77, s36, v209
    v_mul_f32 v180, v180, v74
    v_mul_f32 v181, v181, v75
    v_mul_f32 v182, v182, v76
    v_mul_f32 v183, v183, v77
    v_cvt_pk_bf16_f32 v72, v180, v181
    v_cvt_pk_bf16_f32 v73, v182, v183
    v_lshlrev_b32 v180, 16, v72
    v_and_b32 v181, s36, v72
    v_lshlrev_b32 v74, 16, v200
    v_and_b32 v75, s36, v200
    v_lshlrev_b32 v182, 16, v73
    v_and_b32 v183, s36, v73
    v_lshlrev_b32 v76, 16, v201
    v_and_b32 v77, s36, v201
    v_add_f32 v180, v180, v74
    v_add_f32 v181, v181, v75
    v_add_f32 v182, v182, v76
    v_add_f32 v183, v183, v77
    v_cvt_pk_bf16_f32 v128, v180, v181
    v_cvt_pk_bf16_f32 v129, v182, v183
    s_add_u32 s32, s35, 32768
    buffer_store_dwordx2 v[128:129], v113, s[24:27], s32 offen
    v_mul_f32 v72, v195, v195
    v_mul_f32 v184, v184, v72
    v_mul_f32 v185, v185, v72
    v_mul_f32 v186, v186, v72
    v_mul_f32 v187, v187, v72
    v_cvt_pk_bf16_f32 v72, v184, v185
    v_cvt_pk_bf16_f32 v73, v186, v187
    v_lshlrev_b32 v184, 16, v72
    v_and_b32 v185, s36, v72
    v_lshlrev_b32 v186, 16, v73
    v_and_b32 v187, s36, v73
    v_mul_f32 v74, 0xbfb8aa3b, v184
    v_mul_f32 v75, 0xbfb8aa3b, v185
    v_mul_f32 v76, 0xbfb8aa3b, v186
    v_mul_f32 v77, 0xbfb8aa3b, v187
    v_exp_f32 v74, v74
    v_exp_f32 v75, v75
    v_exp_f32 v76, v76
    v_exp_f32 v77, v77
    v_add_f32 v74, 1.0, v74
    v_add_f32 v75, 1.0, v75
    v_add_f32 v76, 1.0, v76
    v_add_f32 v77, 1.0, v77
    v_rcp_f32 v74, v74
    v_rcp_f32 v75, v75
    v_rcp_f32 v76, v76
    v_rcp_f32 v77, v77
    v_mul_f32 v184, v184, v74
    v_mul_f32 v185, v185, v75
    v_mul_f32 v186, v186, v76
    v_mul_f32 v187, v187, v77
    v_cvt_pk_bf16_f32 v72, v184, v185
    v_cvt_pk_bf16_f32 v73, v186, v187
    v_lshlrev_b32 v184, 16, v72
    v_and_b32 v185, s36, v72
    v_lshlrev_b32 v74, 16, v210
    v_and_b32 v75, s36, v210
    v_lshlrev_b32 v186, 16, v73
    v_and_b32 v187, s36, v73
    v_lshlrev_b32 v76, 16, v211
    v_and_b32 v77, s36, v211
    v_mul_f32 v184, v184, v74
    v_mul_f32 v185, v185, v75
    v_mul_f32 v186, v186, v76
    v_mul_f32 v187, v187, v77
    v_cvt_pk_bf16_f32 v72, v184, v185
    v_cvt_pk_bf16_f32 v73, v186, v187
    v_lshlrev_b32 v184, 16, v72
    v_and_b32 v185, s36, v72
    v_lshlrev_b32 v74, 16, v202
    v_and_b32 v75, s36, v202
    v_lshlrev_b32 v186, 16, v73
    v_and_b32 v187, s36, v73
    v_lshlrev_b32 v76, 16, v203
    v_and_b32 v77, s36, v203
    v_add_f32 v184, v184, v74
    v_add_f32 v185, v185, v75
    v_add_f32 v186, v186, v76
    v_add_f32 v187, v187, v77
    v_cvt_pk_bf16_f32 v130, v184, v185
    v_cvt_pk_bf16_f32 v131, v186, v187
    s_add_u32 s32, s35, 49152
    buffer_store_dwordx2 v[130:131], v113, s[24:27], s32 offen
    s_endpgm
F_H:
    s_load_dwordx2 s[4:5], s[0:1], 0
    s_load_dwordx4 s[8:11], s[0:1], 80
    s_load_dwordx2 s[6:7], s[0:1], 120
    s_load_dwordx4 s[12:15], s[0:1], 8
    s_load_dwordx4 s[16:19], s[0:1], 24
    s_load_dwordx4 s[20:23], s[0:1], 40
    s_load_dwordx4 s[24:27], s[0:1], 56
    s_load_dwordx2 s[64:65], s[0:1], 96
    s_sub_u32 s44, s3, 4
    s_and_b32 s47, s2, 1
    s_lshl_b32 s47, s47, 3
    s_lshr_b32 s48, s2, 3
    s_and_b32 s45, s48, 7
    s_add_u32 s45, s45, s47
    s_bfe_u32 s47, s2, 131073
    s_lshl_b32 s47, s47, 2
    s_lshr_b32 s46, s2, 6
    s_add_u32 s46, s46, s47
    s_mov_b32 s50, 0xffff0000
    v_mov_b32 v6, 0
    v_lshlrev_b32 v2, 2, v1
    v_add_u32 v2, 163712, v2
    s_mov_b64 exec, 0xffffffff
    ds_write_b32 v2, v6
    s_mov_b64 exec, -1
    v_lshlrev_b32 v8, 4, v1
    s_and_b32 s47, s2, 7
    s_lshl_b32 s47, s47, 5
    s_lshr_b32 s48, s2, 3
    s_add_u32 s47, s47, s48
    s_lshr_b32 s58, s44, 1
    s_and_b32 s60, s44, 1
    s_lshl_b32 s59, s47, 1
    s_add_u32 s59, s59, s58
    s_mul_i32 s61, s44, 9216
    s_add_u32 s61, s61, 94336
    s_xor_b32 s47, s44, 1
    s_mul_i32 s62, s47, 9216
    s_add_u32 s62, s62, 94336
    s_mul_i32 s63, s58, 8320
    s_add_u32 s63, s63, 141504
    s_mul_i32 s55, s58, 4608
    s_add_u32 s55, s55, 47168
    s_waitcnt lgkmcnt(0)
    s_lshl_b32 s47, s59, 8
    v_lshlrev_b32 v11, 1, v1
    v_add_u32 v11, s47, v11
    s_lshl_b32 s47, s60, 7
    v_add_u32 v11, s47, v11
    global_load_ushort v12, v11, s[12:13]
    global_load_ushort v13, v11, s[14:15]
    global_load_ushort v14, v11, s[16:17]
    global_load_ushort v15, v11, s[18:19]
    global_load_ushort v16, v11, s[20:21]
    global_load_ushort v17, v11, s[22:23]
    s_lshl_b32 s47, s59, 1
    v_mov_b32 v11, s47
    global_load_ushort v18, v11, s[24:25]
    global_load_ushort v19, v11, s[26:27]
    s_mov_b32 s40, s6
    s_and_b32 s41, s7, 65535
    s_mov_b32 s42, 0xe00000
    s_mov_b32 s43, 0x20000
    v_mov_b32 v2, 0
    s_mov_b32 s47, 13697024
    buffer_load_dword v9, v2, s[40:43], s47 offen sc1
    s_setprio 2
    s_lshr_b32 s47, s2, 6
    s_lshl_b32 s47, s47, 5
    s_lshl_b32 s48, s45, 7
    s_add_u32 s47, s47, s48
    v_add_u32 v2, s47, v1
    v_lshlrev_b32 v2, 10, v2
    s_lshl_b32 s47, s44, 7
    v_add_u32 v2, s47, v2
    v_bfe_u32 v3, v1, 1, 3
    s_bfe_u32 s47, s2, 196611
    s_lshl_b32 s47, s47, 3
    s_lshl_b32 s48, s44, 6
    s_add_u32 s47, s47, s48
    v_add_u32 v3, s47, v3
    v_mul_u32_u24 v3, 3584, v3
    v_and_b32 v4, 1, v1
    v_lshl_add_u32 v3, v4, 7, v3
    s_mul_i32 s47, s46, 224
    v_add_u32 v3, s47, v3
    v_cmp_gt_u32 vcc, 32, v1
    s_nop 1
    v_cndmask_b32 v2, v3, v2, vcc
    v_mov_b32 v11, 917504
    v_mov_b32 v4, 512
    v_cndmask_b32 v11, v11, v4, vcc
    v_mov_b32 v20, s10
    v_mov_b32 v21, s11
    v_cmp_gt_u32 vcc, 48, v1
    v_mov_b32 v3, s8
    v_mov_b32 v4, s9
    v_cndmask_b32 v20, v20, v3, vcc
    v_cndmask_b32 v21, v21, v4, vcc
    v_cmp_gt_u32 vcc, 32, v1
    v_mov_b32 v3, s4
    v_mov_b32 v4, s5
    v_cndmask_b32 v20, v20, v3, vcc
    v_cndmask_b32 v21, v21, v4, vcc
    v_add_co_u32 v20, vcc, v20, v2
    s_nop 1
    v_addc_co_u32 v21, vcc, 0, v21, vcc
    s_mov_b32 s28, s4
    s_and_b32 s29, s5, 65535
    s_mov_b32 s30, 0x200000
    s_mov_b32 s31, 0x20000
    s_mov_b32 s32, s8
    s_and_b32 s33, s9, 65535
    s_mov_b32 s34, 0x1c0000
    s_mov_b32 s35, 0x20000
    s_mov_b32 s36, s10
    s_and_b32 s37, s11, 65535
    s_mov_b32 s38, 0x1c0000
    s_mov_b32 s39, 0x20000
    s_barrier
    s_and_b32 s47, s44, 1
    s_lshl_b32 s47, s47, 2
    v_lshrrev_b32 v2, 4, v1
    v_add_u32 v2, s47, v2
    v_and_b32 v3, 7, v1
    v_xor_b32 v2, v2, v3
    v_lshlrev_b32 v2, 4, v2
    v_lshrrev_b32 v3, 3, v1
    v_lshl_add_u32 v22, v3, 10, v2
    s_lshl_b32 s47, s44, 6
    v_add_u32 v2, s47, v1
    v_mul_u32_u24 v3, 4370, v2
    v_lshrrev_b32 v3, 16, v3
    v_mul_u32_u24 v4, 15, v3
    v_sub_u32 v4, v2, v4
    v_min_u32 v4, 13, v4
    v_mul_u32_u24 v3, 3584, v3
    v_lshl_add_u32 v23, v4, 4, v3
    v_add_u32 v2, s47, v1
    v_add_u32 v2, 256, v2
    v_mul_u32_u24 v3, 4370, v2
    v_lshrrev_b32 v3, 16, v3
    v_mul_u32_u24 v4, 15, v3
    v_sub_u32 v4, v2, v4
    v_min_u32 v4, 13, v4
    v_mul_u32_u24 v3, 3584, v3
    v_lshl_add_u32 v24, v4, 4, v3
    v_add_u32 v2, s47, v1
    v_add_u32 v2, 512, v2
    v_mul_u32_u24 v3, 4370, v2
    v_lshrrev_b32 v3, 16, v3
    v_mul_u32_u24 v4, 15, v3
    v_sub_u32 v4, v2, v4
    v_min_u32 v4, 13, v4
    v_mul_u32_u24 v3, 3584, v3
    v_lshl_add_u32 v25, v4, 4, v3
    v_add_u32 v2, s47, v1
    v_add_u32 v2, 768, v2
    v_mul_u32_u24 v3, 4370, v2
    v_lshrrev_b32 v3, 16, v3
    v_mul_u32_u24 v4, 15, v3
    v_sub_u32 v4, v2, v4
    v_min_u32 v4, 13, v4
    v_mul_u32_u24 v3, 3584, v3
    v_lshl_add_u32 v26, v4, 4, v3
    s_cmp_eq_u32 s44, 3
    s_cselect_b64 s[56:57], 0, -1
    s_lshl_b32 s52, s45, 17
    s_lshl_b32 s47, s44, 13
    s_add_u32 s52, s52, s47
    s_mul_i32 s53, s46, 224
    s_lshl_b32 s54, s44, 10
    v_lshrrev_b32 v2, 4, v1
    v_lshlrev_b32 v2, 1, v2
    v_and_b32 v2, 6, v2
    v_and_b32 v3, 7, v1
    v_xor_b32 v2, v2, v3
    v_lshlrev_b32 v2, 4, v2
    v_lshrrev_b32 v3, 3, v1
    v_lshl_add_u32 v10, v3, 10, v2
    v_mov_b32 v28, 0
    v_mov_b32 v29, 0
    v_mov_b32 v30, 0
    v_mov_b32 v31, 0
    s_cmp_eq_u32 s60, 0
    s_cbranch_scc0 F_ZK_36
    v_add_u32 v2, s63, v8
    s_mov_b64 exec, 0xf
    ds_write_b128 v2, v[28:31] offset:4096
    ds_write_b128 v2, v[28:31] offset:8256
    s_mov_b64 exec, -1
F_ZK_36:
    s_add_u32 m0, s54, 0
    s_add_u32 s47, s52, 0
    buffer_load_dwordx4 v22, s[28:31], s47 offen lds
    s_add_u32 m0, s54, 4096
    s_add_u32 s47, s52, 32768
    buffer_load_dwordx4 v22, s[28:31], s47 offen lds
    s_add_u32 m0, s54, 8192
    s_add_u32 s47, s52, 65536
    buffer_load_dwordx4 v22, s[28:31], s47 offen lds
    s_add_u32 m0, s54, 12288
    s_add_u32 s47, s52, 98304
    buffer_load_dwordx4 v22, s[28:31], s47 offen lds
    s_add_u32 s48, s53, 0
    s_add_u32 m0, s54, 16384
    s_nop 0
    buffer_load_dwordx4 v23, s[32:35], s48 offen lds
    s_add_u32 m0, s54, 31808
    s_nop 0
    buffer_load_dwordx4 v23, s[36:39], s48 offen lds
    s_add_u32 m0, s54, 20480
    s_nop 0
    buffer_load_dwordx4 v24, s[32:35], s48 offen lds
    s_add_u32 m0, s54, 35904
    s_nop 0
    buffer_load_dwordx4 v24, s[36:39], s48 offen lds
    s_add_u32 m0, s54, 24576
    s_nop 0
    buffer_load_dwordx4 v25, s[32:35], s48 offen lds
    s_add_u32 m0, s54, 40000
    s_nop 0
    buffer_load_dwordx4 v25, s[36:39], s48 offen lds
    s_mov_b64 exec, s[56:57]
    s_add_u32 m0, s54, 28672
    s_nop 0
    buffer_load_dwordx4 v26, s[32:35], s48 offen lds
    s_add_u32 m0, s54, 44096
    s_nop 0
    buffer_load_dwordx4 v26, s[36:39], s48 offen lds
    s_mov_b64 exec, -1
    s_waitcnt vmcnt(12)
    v_readfirstlane_b32 s51, v9
    s_nop 0
    s_mul_i32 s51, s51, 0x9E3779B5
    s_add_u32 s51, s51, 0x7F4A7C15
    s_mov_b32 s12, s64
    s_and_b32 s13, s65, 65535
    s_mov_b32 s14, 0x1c0000
    s_mov_b32 s15, 0x20000
    s_lshr_b32 s17, s2, 5
    s_lshl_b32 s17, s17, 7
    s_lshl_b32 s49, s44, 13
    s_add_u32 s17, s17, s49
    s_lshr_b32 s47, s2, 3
    s_mul_i32 s47, s47, 57344
    s_mul_i32 s48, s44, 14336
    s_add_u32 s24, s47, s48
    v_lshlrev_b32 v27, 7, v1
    s_lshl_b32 s18, s44, 12
    s_add_u32 s18, s18, 56384
    s_xor_b32 s19, s44, 1
    s_lshl_b32 s19, s19, 12
    s_add_u32 s19, s19, 56384
    s_lshl_b32 s47, s58, 4
    s_add_u32 s47, s47, 163712
    v_mov_b32 v5, s47
    v_lshlrev_b32 v31, 16, v18
    v_mul_f32 v31, 0x3fb8aa3b, v31
    v_exp_f32 v31, v31
    v_lshlrev_b32 v32, 16, v19
    v_lshlrev_b32 v12, 16, v12
    v_lshlrev_b32 v13, 16, v13
    v_lshlrev_b32 v14, 16, v14
    v_lshlrev_b32 v15, 16, v15
    v_lshlrev_b32 v16, 16, v16
    v_lshlrev_b32 v17, 16, v17
    v_cvt_pk_bf16_f32 v31, v31, v31
    v_lshlrev_b32 v31, 16, v31
    v_and_b32 v33, 15, v1
    v_lshrrev_b32 v34, 4, v1
    v_lshlrev_b32 v34, 4, v34
    v_add_u32 v34, s61, v34
    v_mul_f32 v35, v31, v12
    v_mul_f32 v36, v31, v13
    v_mul_f32 v35, 0x3fb8aa3b, v35
    v_mul_f32 v36, 0x3e22f983, v36
    v_mul_f32 v40, v31, v14
    v_mul_f32 v41, v31, v15
    v_pk_mul_f32 v[38:39], v[16:17], v[40:41] op_sel_hi:[1,0]
    v_pk_fma_f32 v[38:39], v[16:17], v[40:41], v[38:39] op_sel:[1,1,0] op_sel_hi:[0,1,1] neg_lo:[1,0,0]
    s_mov_b32 m0, s61
    v_mov_b32 v44, 0x3f80
    ds_write_addtid_b32 v44 offset:0
    v_mul_f32 v40, 0x41800000, v35
    v_mul_f32 v41, 0x41800000, v36
    v_exp_f32 v40, v40
    v_fract_f32 v41, v41
    v_cos_f32 v42, v41
    v_sin_f32 v41, v41
    v_mul_f32 v48, v40, v42
    v_mul_f32_e64 v49, v40, -v41
    v_cvt_pk_bf16_f32 v45, v48, v49
    ds_write_addtid_b32 v45 offset:288
    v_pk_mul_f32 v[50:51], v[48:49], v[48:49] op_sel_hi:[1,0]
    v_pk_fma_f32 v[50:51], v[48:49], v[48:49], v[50:51] op_sel:[1,1,0] op_sel_hi:[0,1,1] neg_lo:[1,0,0]
    v_cvt_pk_bf16_f32 v44, v50, v51
    ds_write_addtid_b32 v44 offset:576
    v_pk_mul_f32 v[52:53], v[50:51], v[48:49] op_sel_hi:[1,0]
    v_pk_fma_f32 v[52:53], v[50:51], v[48:49], v[52:53] op_sel:[1,1,0] op_sel_hi:[0,1,1] neg_lo:[1,0,0]
    v_cvt_pk_bf16_f32 v45, v52, v53
    ds_write_addtid_b32 v45 offset:864
    v_pk_mul_f32 v[54:55], v[50:51], v[50:51] op_sel_hi:[1,0]
    v_pk_fma_f32 v[54:55], v[50:51], v[50:51], v[54:55] op_sel:[1,1,0] op_sel_hi:[0,1,1] neg_lo:[1,0,0]
    v_cvt_pk_bf16_f32 v44, v54, v55
    ds_write_addtid_b32 v44 offset:1152
    v_pk_mul_f32 v[56:57], v[54:55], v[48:49] op_sel_hi:[1,0]
    v_pk_fma_f32 v[56:57], v[54:55], v[48:49], v[56:57] op_sel:[1,1,0] op_sel_hi:[0,1,1] neg_lo:[1,0,0]
    v_cvt_pk_bf16_f32 v45, v56, v57
    ds_write_addtid_b32 v45 offset:1440
    v_pk_mul_f32 v[58:59], v[52:53], v[52:53] op_sel_hi:[1,0]
    v_pk_fma_f32 v[58:59], v[52:53], v[52:53], v[58:59] op_sel:[1,1,0] op_sel_hi:[0,1,1] neg_lo:[1,0,0]
    v_cvt_pk_bf16_f32 v44, v58, v59
    ds_write_addtid_b32 v44 offset:1728
    v_pk_mul_f32 v[60:61], v[58:59], v[48:49] op_sel_hi:[1,0]
    v_pk_fma_f32 v[60:61], v[58:59], v[48:49], v[60:61] op_sel:[1,1,0] op_sel_hi:[0,1,1] neg_lo:[1,0,0]
    v_cvt_pk_bf16_f32 v45, v60, v61
    ds_write_addtid_b32 v45 offset:2016
    v_pk_mul_f32 v[62:63], v[54:55], v[54:55] op_sel_hi:[1,0]
    v_pk_fma_f32 v[62:63], v[54:55], v[54:55], v[62:63] op_sel:[1,1,0] op_sel_hi:[0,1,1] neg_lo:[1,0,0]
    v_cvt_pk_bf16_f32 v44, v62, v63
    ds_write_addtid_b32 v44 offset:2304
    v_pk_mul_f32 v[64:65], v[62:63], v[48:49] op_sel_hi:[1,0]
    v_pk_fma_f32 v[64:65], v[62:63], v[48:49], v[64:65] op_sel:[1,1,0] op_sel_hi:[0,1,1] neg_lo:[1,0,0]
    v_cvt_pk_bf16_f32 v45, v64, v65
    ds_write_addtid_b32 v45 offset:2592
    v_pk_mul_f32 v[66:67], v[56:57], v[56:57] op_sel_hi:[1,0]
    v_pk_fma_f32 v[66:67], v[56:57], v[56:57], v[66:67] op_sel:[1,1,0] op_sel_hi:[0,1,1] neg_lo:[1,0,0]
    v_cvt_pk_bf16_f32 v44, v66, v67
    ds_write_addtid_b32 v44 offset:2880
    v_pk_mul_f32 v[68:69], v[66:67], v[48:49] op_sel_hi:[1,0]
    v_pk_fma_f32 v[68:69], v[66:67], v[48:49], v[68:69] op_sel:[1,1,0] op_sel_hi:[0,1,1] neg_lo:[1,0,0]
    v_cvt_pk_bf16_f32 v45, v68, v69
    ds_write_addtid_b32 v45 offset:3168
    v_pk_mul_f32 v[70:71], v[58:59], v[58:59] op_sel_hi:[1,0]
    v_pk_fma_f32 v[70:71], v[58:59], v[58:59], v[70:71] op_sel:[1,1,0] op_sel_hi:[0,1,1] neg_lo:[1,0,0]
    v_cvt_pk_bf16_f32 v44, v70, v71
    ds_write_addtid_b32 v44 offset:3456
    v_pk_mul_f32 v[72:73], v[70:71], v[48:49] op_sel_hi:[1,0]
    v_pk_fma_f32 v[72:73], v[70:71], v[48:49], v[72:73] op_sel:[1,1,0] op_sel_hi:[0,1,1] neg_lo:[1,0,0]
    v_cvt_pk_bf16_f32 v45, v72, v73
    ds_write_addtid_b32 v45 offset:3744
    v_pk_mul_f32 v[74:75], v[60:61], v[60:61] op_sel_hi:[1,0]
    v_pk_fma_f32 v[74:75], v[60:61], v[60:61], v[74:75] op_sel:[1,1,0] op_sel_hi:[0,1,1] neg_lo:[1,0,0]
    v_cvt_pk_bf16_f32 v44, v74, v75
    ds_write_addtid_b32 v44 offset:4032
    v_pk_mul_f32 v[76:77], v[74:75], v[48:49] op_sel_hi:[1,0]
    v_pk_fma_f32 v[76:77], v[74:75], v[48:49], v[76:77] op_sel:[1,1,0] op_sel_hi:[0,1,1] neg_lo:[1,0,0]
    v_cvt_pk_bf16_f32 v45, v76, v77
    ds_write_addtid_b32 v45 offset:4320
    v_pk_mul_f32 v[78:79], v[62:63], v[62:63] op_sel_hi:[1,0]
    v_pk_fma_f32 v[78:79], v[62:63], v[62:63], v[78:79] op_sel:[1,1,0] op_sel_hi:[0,1,1] neg_lo:[1,0,0]
    v_cvt_pk_bf16_f32 v44, v78, v79
    ds_write_addtid_b32 v44 offset:4608
    v_pk_mul_f32 v[80:81], v[64:65], v[64:65] op_sel_hi:[1,0]
    v_pk_fma_f32 v[80:81], v[64:65], v[64:65], v[80:81] op_sel:[1,1,0] op_sel_hi:[0,1,1] neg_lo:[1,0,0]
    v_cvt_pk_bf16_f32 v45, v80, v81
    ds_write_addtid_b32 v45 offset:4896
    v_pk_mul_f32 v[82:83], v[66:67], v[66:67] op_sel_hi:[1,0]
    v_pk_fma_f32 v[82:83], v[66:67], v[66:67], v[82:83] op_sel:[1,1,0] op_sel_hi:[0,1,1] neg_lo:[1,0,0]
    v_cvt_pk_bf16_f32 v44, v82, v83
    ds_write_addtid_b32 v44 offset:5184
    v_pk_mul_f32 v[84:85], v[68:69], v[68:69] op_sel_hi:[1,0]
    v_pk_fma_f32 v[84:85], v[68:69], v[68:69], v[84:85] op_sel:[1,1,0] op_sel_hi:[0,1,1] neg_lo:[1,0,0]
    v_cvt_pk_bf16_f32 v45, v84, v85
    ds_write_addtid_b32 v45 offset:5472
    v_pk_mul_f32 v[86:87], v[70:71], v[70:71] op_sel_hi:[1,0]
    v_pk_fma_f32 v[86:87], v[70:71], v[70:71], v[86:87] op_sel:[1,1,0] op_sel_hi:[0,1,1] neg_lo:[1,0,0]
    v_cvt_pk_bf16_f32 v44, v86, v87
    ds_write_addtid_b32 v44 offset:5760
    v_pk_mul_f32 v[88:89], v[72:73], v[72:73] op_sel_hi:[1,0]
    v_pk_fma_f32 v[88:89], v[72:73], v[72:73], v[88:89] op_sel:[1,1,0] op_sel_hi:[0,1,1] neg_lo:[1,0,0]
    v_cvt_pk_bf16_f32 v45, v88, v89
    ds_write_addtid_b32 v45 offset:6048
    v_pk_mul_f32 v[90:91], v[74:75], v[74:75] op_sel_hi:[1,0]
    v_pk_fma_f32 v[90:91], v[74:75], v[74:75], v[90:91] op_sel:[1,1,0] op_sel_hi:[0,1,1] neg_lo:[1,0,0]
    v_cvt_pk_bf16_f32 v44, v90, v91
    ds_write_addtid_b32 v44 offset:6336
    v_pk_mul_f32 v[92:93], v[76:77], v[76:77] op_sel_hi:[1,0]
    v_pk_fma_f32 v[92:93], v[76:77], v[76:77], v[92:93] op_sel:[1,1,0] op_sel_hi:[0,1,1] neg_lo:[1,0,0]
    v_cvt_pk_bf16_f32 v45, v92, v93
    ds_write_addtid_b32 v45 offset:6624
    v_pk_mul_f32 v[94:95], v[78:79], v[78:79] op_sel_hi:[1,0]
    v_pk_fma_f32 v[94:95], v[78:79], v[78:79], v[94:95] op_sel:[1,1,0] op_sel_hi:[0,1,1] neg_lo:[1,0,0]
    v_cvt_pk_bf16_f32 v44, v94, v95
    ds_write_addtid_b32 v44 offset:6912
    v_pk_mul_f32 v[96:97], v[80:81], v[80:81] op_sel_hi:[1,0]
    v_pk_fma_f32 v[96:97], v[80:81], v[80:81], v[96:97] op_sel:[1,1,0] op_sel_hi:[0,1,1] neg_lo:[1,0,0]
    v_cvt_pk_bf16_f32 v45, v96, v97
    ds_write_addtid_b32 v45 offset:7200
    v_pk_mul_f32 v[98:99], v[82:83], v[82:83] op_sel_hi:[1,0]
    v_pk_fma_f32 v[98:99], v[82:83], v[82:83], v[98:99] op_sel:[1,1,0] op_sel_hi:[0,1,1] neg_lo:[1,0,0]
    v_cvt_pk_bf16_f32 v44, v98, v99
    ds_write_addtid_b32 v44 offset:7488
    v_pk_mul_f32 v[100:101], v[84:85], v[84:85] op_sel_hi:[1,0]
    v_pk_fma_f32 v[100:101], v[84:85], v[84:85], v[100:101] op_sel:[1,1,0] op_sel_hi:[0,1,1] neg_lo:[1,0,0]
    v_cvt_pk_bf16_f32 v45, v100, v101
    ds_write_addtid_b32 v45 offset:7776
    v_pk_mul_f32 v[102:103], v[86:87], v[86:87] op_sel_hi:[1,0]
    v_pk_fma_f32 v[102:103], v[86:87], v[86:87], v[102:103] op_sel:[1,1,0] op_sel_hi:[0,1,1] neg_lo:[1,0,0]
    v_cvt_pk_bf16_f32 v44, v102, v103
    ds_write_addtid_b32 v44 offset:8064
    v_pk_mul_f32 v[104:105], v[88:89], v[88:89] op_sel_hi:[1,0]
    v_pk_fma_f32 v[104:105], v[88:89], v[88:89], v[104:105] op_sel:[1,1,0] op_sel_hi:[0,1,1] neg_lo:[1,0,0]
    v_cvt_pk_bf16_f32 v45, v104, v105
    ds_write_addtid_b32 v45 offset:8352
    v_pk_mul_f32 v[106:107], v[90:91], v[90:91] op_sel_hi:[1,0]
    v_pk_fma_f32 v[106:107], v[90:91], v[90:91], v[106:107] op_sel:[1,1,0] op_sel_hi:[0,1,1] neg_lo:[1,0,0]
    v_cvt_pk_bf16_f32 v44, v106, v107
    ds_write_addtid_b32 v44 offset:8640
    v_pk_mul_f32 v[108:109], v[92:93], v[92:93] op_sel_hi:[1,0]
    v_pk_fma_f32 v[108:109], v[92:93], v[92:93], v[108:109] op_sel:[1,1,0] op_sel_hi:[0,1,1] neg_lo:[1,0,0]
    v_cvt_pk_bf16_f32 v45, v108, v109
    ds_write_addtid_b32 v45 offset:8928
    v_mul_u32_u24 v110, 288, v33
    v_add_u32 v110, v110, v34
    v_lshlrev_b32 v28, 1, v33
    v_add_u32 v29, 8, v33
    v_min_u32 v28, v28, v29
    v_mul_u32_u24 v111, 288, v28
    v_add_u32 v111, v111, v34
    v_lshlrev_b32 v28, 2, v33
    v_lshlrev_b32 v29, 1, v33
    v_add_u32 v29, 8, v29
    v_min_u32 v28, v28, v29
    v_add_u32 v29, 16, v33
    v_min_u32 v28, v28, v29
    v_mul_u32_u24 v112, 288, v28
    v_add_u32 v112, v112, v34
    v_mul_f32 v40, 1.0, v35
    v_mul_f32 v41, 1.0, v36
    v_exp_f32 v40, v40
    v_fract_f32 v41, v41
    v_cos_f32 v42, v41
    v_sin_f32 v41, v41
    v_mul_f32 v114, v40, v42
    v_mul_f32 v115, v40, v41
    v_pk_mul_f32 v[116:117], v[114:115], v[114:115] op_sel_hi:[1,0]
    v_pk_fma_f32 v[116:117], v[114:115], v[114:115], v[116:117] op_sel:[1,1,0] op_sel_hi:[0,1,1] neg_lo:[1,0,0]
    v_pk_mul_f32 v[118:119], v[116:117], v[116:117] op_sel_hi:[1,0]
    v_pk_fma_f32 v[118:119], v[116:117], v[116:117], v[118:119] op_sel:[1,1,0] op_sel_hi:[0,1,1] neg_lo:[1,0,0]
    v_pk_mul_f32 v[120:121], v[118:119], v[118:119] op_sel_hi:[1,0]
    v_pk_fma_f32 v[120:121], v[118:119], v[118:119], v[120:121] op_sel:[1,1,0] op_sel_hi:[0,1,1] neg_lo:[1,0,0]
    v_pk_mul_f32 v[124:125], v[38:39], v[78:79] op_sel_hi:[1,0]
    v_pk_fma_f32 v[124:125], v[38:39], v[78:79], v[124:125] op_sel:[1,1,0] op_sel_hi:[0,1,1] neg_hi:[1,0,0]
    v_pk_mul_f32 v[126:127], v[38:39], v[94:95] op_sel_hi:[1,0]
    v_pk_fma_f32 v[126:127], v[38:39], v[94:95], v[126:127] op_sel:[1,1,0] op_sel_hi:[0,1,1] neg_hi:[1,0,0]
    v_pk_mul_f32 v[128:129], v[126:127], v[94:95] op_sel_hi:[1,0]
    v_pk_fma_f32 v[128:129], v[126:127], v[94:95], v[128:129] op_sel:[1,1,0] op_sel_hi:[0,1,1] neg_hi:[1,0,0]
    s_waitcnt lgkmcnt(0)
    ds_read_b128 v[132:135], v110 offset:0
    ds_read_b128 v[136:139], v110 offset:64
    ds_read_b128 v[140:143], v110 offset:128
    ds_read_b128 v[144:147], v110 offset:192
    ds_read_b128 v[148:151], v111 offset:0
    ds_read_b128 v[152:155], v111 offset:64
    ds_read_b128 v[156:159], v111 offset:128
    ds_read_b128 v[160:163], v111 offset:192
    ds_read_b128 v[164:167], v112 offset:0
    ds_read_b128 v[168:171], v112 offset:64
    ds_read_b128 v[172:175], v112 offset:128
    ds_read_b128 v[176:179], v112 offset:192
    s_waitcnt lgkmcnt(0)
    v_cvt_pk_bf16_f32 v44, v38, v39
    ds_write_addtid_b32 v44 offset:0
    v_pk_mul_f32 v[46:47], v[38:39], v[114:115] op_sel_hi:[1,0]
    v_pk_fma_f32 v[46:47], v[38:39], v[114:115], v[46:47] op_sel:[1,1,0] op_sel_hi:[0,1,1] neg_lo:[1,0,0]
    v_cvt_pk_bf16_f32 v45, v46, v47
    ds_write_addtid_b32 v45 offset:288
    v_pk_mul_f32 v[48:49], v[46:47], v[114:115] op_sel_hi:[1,0]
    v_pk_fma_f32 v[48:49], v[46:47], v[114:115], v[48:49] op_sel:[1,1,0] op_sel_hi:[0,1,1] neg_lo:[1,0,0]
    v_cvt_pk_bf16_f32 v44, v48, v49
    ds_write_addtid_b32 v44 offset:576
    v_pk_mul_f32 v[46:47], v[48:49], v[114:115] op_sel_hi:[1,0]
    v_pk_fma_f32 v[46:47], v[48:49], v[114:115], v[46:47] op_sel:[1,1,0] op_sel_hi:[0,1,1] neg_lo:[1,0,0]
    v_cvt_pk_bf16_f32 v45, v46, v47
    ds_write_addtid_b32 v45 offset:864
    v_pk_mul_f32 v[48:49], v[46:47], v[114:115] op_sel_hi:[1,0]
    v_pk_fma_f32 v[48:49], v[46:47], v[114:115], v[48:49] op_sel:[1,1,0] op_sel_hi:[0,1,1] neg_lo:[1,0,0]
    v_cvt_pk_bf16_f32 v44, v48, v49
    ds_write_addtid_b32 v44 offset:1152
    v_pk_mul_f32 v[46:47], v[48:49], v[114:115] op_sel_hi:[1,0]
    v_pk_fma_f32 v[46:47], v[48:49], v[114:115], v[46:47] op_sel:[1,1,0] op_sel_hi:[0,1,1] neg_lo:[1,0,0]
    v_cvt_pk_bf16_f32 v45, v46, v47
    ds_write_addtid_b32 v45 offset:1440
    v_pk_mul_f32 v[48:49], v[46:47], v[114:115] op_sel_hi:[1,0]
    v_pk_fma_f32 v[48:49], v[46:47], v[114:115], v[48:49] op_sel:[1,1,0] op_sel_hi:[0,1,1] neg_lo:[1,0,0]
    v_cvt_pk_bf16_f32 v44, v48, v49
    ds_write_addtid_b32 v44 offset:1728
    v_pk_mul_f32 v[46:47], v[48:49], v[114:115] op_sel_hi:[1,0]
    v_pk_fma_f32 v[46:47], v[48:49], v[114:115], v[46:47] op_sel:[1,1,0] op_sel_hi:[0,1,1] neg_lo:[1,0,0]
    v_cvt_pk_bf16_f32 v45, v46, v47
    ds_write_addtid_b32 v45 offset:2016
    v_pk_mul_f32 v[48:49], v[46:47], v[114:115] op_sel_hi:[1,0]
    v_pk_fma_f32 v[48:49], v[46:47], v[114:115], v[48:49] op_sel:[1,1,0] op_sel_hi:[0,1,1] neg_lo:[1,0,0]
    v_cvt_pk_bf16_f32 v44, v48, v49
    ds_write_addtid_b32 v44 offset:2304
    v_pk_mul_f32 v[46:47], v[48:49], v[114:115] op_sel_hi:[1,0]
    v_pk_fma_f32 v[46:47], v[48:49], v[114:115], v[46:47] op_sel:[1,1,0] op_sel_hi:[0,1,1] neg_lo:[1,0,0]
    v_cvt_pk_bf16_f32 v45, v46, v47
    ds_write_addtid_b32 v45 offset:2592
    v_pk_mul_f32 v[48:49], v[46:47], v[114:115] op_sel_hi:[1,0]
    v_pk_fma_f32 v[48:49], v[46:47], v[114:115], v[48:49] op_sel:[1,1,0] op_sel_hi:[0,1,1] neg_lo:[1,0,0]
    v_cvt_pk_bf16_f32 v44, v48, v49
    ds_write_addtid_b32 v44 offset:2880
    v_pk_mul_f32 v[46:47], v[48:49], v[114:115] op_sel_hi:[1,0]
    v_pk_fma_f32 v[46:47], v[48:49], v[114:115], v[46:47] op_sel:[1,1,0] op_sel_hi:[0,1,1] neg_lo:[1,0,0]
    v_cvt_pk_bf16_f32 v45, v46, v47
    ds_write_addtid_b32 v45 offset:3168
    v_pk_mul_f32 v[48:49], v[46:47], v[114:115] op_sel_hi:[1,0]
    v_pk_fma_f32 v[48:49], v[46:47], v[114:115], v[48:49] op_sel:[1,1,0] op_sel_hi:[0,1,1] neg_lo:[1,0,0]
    v_cvt_pk_bf16_f32 v44, v48, v49
    ds_write_addtid_b32 v44 offset:3456
    v_pk_mul_f32 v[46:47], v[48:49], v[114:115] op_sel_hi:[1,0]
    v_pk_fma_f32 v[46:47], v[48:49], v[114:115], v[46:47] op_sel:[1,1,0] op_sel_hi:[0,1,1] neg_lo:[1,0,0]
    v_cvt_pk_bf16_f32 v45, v46, v47
    ds_write_addtid_b32 v45 offset:3744
    v_pk_mul_f32 v[48:49], v[46:47], v[114:115] op_sel_hi:[1,0]
    v_pk_fma_f32 v[48:49], v[46:47], v[114:115], v[48:49] op_sel:[1,1,0] op_sel_hi:[0,1,1] neg_lo:[1,0,0]
    v_cvt_pk_bf16_f32 v44, v48, v49
    ds_write_addtid_b32 v44 offset:4032
    v_pk_mul_f32 v[46:47], v[48:49], v[114:115] op_sel_hi:[1,0]
    v_pk_fma_f32 v[46:47], v[48:49], v[114:115], v[46:47] op_sel:[1,1,0] op_sel_hi:[0,1,1] neg_lo:[1,0,0]
    v_cvt_pk_bf16_f32 v45, v46, v47
    ds_write_addtid_b32 v45 offset:4320
    v_cvt_pk_bf16_f32 v44, v124, v125
    ds_write_addtid_b32 v44 offset:4608
    v_pk_mul_f32 v[46:47], v[124:125], v[116:117] op_sel_hi:[1,0]
    v_pk_fma_f32 v[46:47], v[124:125], v[116:117], v[46:47] op_sel:[1,1,0] op_sel_hi:[0,1,1] neg_lo:[1,0,0]
    v_cvt_pk_bf16_f32 v45, v46, v47
    ds_write_addtid_b32 v45 offset:4896
    v_pk_mul_f32 v[48:49], v[46:47], v[116:117] op_sel_hi:[1,0]
    v_pk_fma_f32 v[48:49], v[46:47], v[116:117], v[48:49] op_sel:[1,1,0] op_sel_hi:[0,1,1] neg_lo:[1,0,0]
    v_cvt_pk_bf16_f32 v44, v48, v49
    ds_write_addtid_b32 v44 offset:5184
    v_pk_mul_f32 v[46:47], v[48:49], v[116:117] op_sel_hi:[1,0]
    v_pk_fma_f32 v[46:47], v[48:49], v[116:117], v[46:47] op_sel:[1,1,0] op_sel_hi:[0,1,1] neg_lo:[1,0,0]
    v_cvt_pk_bf16_f32 v45, v46, v47
    ds_write_addtid_b32 v45 offset:5472
    v_pk_mul_f32 v[48:49], v[46:47], v[116:117] op_sel_hi:[1,0]
    v_pk_fma_f32 v[48:49], v[46:47], v[116:117], v[48:49] op_sel:[1,1,0] op_sel_hi:[0,1,1] neg_lo:[1,0,0]
    v_cvt_pk_bf16_f32 v44, v48, v49
    ds_write_addtid_b32 v44 offset:5760
    v_pk_mul_f32 v[46:47], v[48:49], v[116:117] op_sel_hi:[1,0]
    v_pk_fma_f32 v[46:47], v[48:49], v[116:117], v[46:47] op_sel:[1,1,0] op_sel_hi:[0,1,1] neg_lo:[1,0,0]
    v_cvt_pk_bf16_f32 v45, v46, v47
    ds_write_addtid_b32 v45 offset:6048
    v_pk_mul_f32 v[48:49], v[46:47], v[116:117] op_sel_hi:[1,0]
    v_pk_fma_f32 v[48:49], v[46:47], v[116:117], v[48:49] op_sel:[1,1,0] op_sel_hi:[0,1,1] neg_lo:[1,0,0]
    v_cvt_pk_bf16_f32 v44, v48, v49
    ds_write_addtid_b32 v44 offset:6336
    v_pk_mul_f32 v[46:47], v[48:49], v[116:117] op_sel_hi:[1,0]
    v_pk_fma_f32 v[46:47], v[48:49], v[116:117], v[46:47] op_sel:[1,1,0] op_sel_hi:[0,1,1] neg_lo:[1,0,0]
    v_cvt_pk_bf16_f32 v45, v46, v47
    ds_write_addtid_b32 v45 offset:6624
    v_pk_mul_f32 v[48:49], v[46:47], v[116:117] op_sel_hi:[1,0]
    v_pk_fma_f32 v[48:49], v[46:47], v[116:117], v[48:49] op_sel:[1,1,0] op_sel_hi:[0,1,1] neg_lo:[1,0,0]
    v_cvt_pk_bf16_f32 v44, v48, v49
    ds_write_addtid_b32 v44 offset:6912
    v_mul_u32_u24 v50, 288, v33
    v_add_u32 v50, v50, v34
    v_bfe_u32 v29, v33, 1, 1
    v_add_u32 v28, v33, v29
    v_add_u32 v28, 0, v28
    v_and_b32 v28, 0xfffffffe, v28
    v_lshrrev_b32 v28, 1, v28
    v_add_u32 v28, 16, v28
    v_mul_u32_u24 v51, 288, v28
    v_add_u32 v51, v51, v34
    v_add_u32 v30, 0, v33
    v_bfe_u32 v29, v30, 2, 1
    v_add_u32 v28, v30, v29
    v_add_u32 v28, 1, v28
    v_and_b32 v28, 0xfffffffc, v28
    v_lshrrev_b32 v28, 2, v28
    v_mul_u32_u24 v52, 288, v28
    v_add_u32 v52, v52, v34
    v_add_u32 v30, 16, v33
    v_bfe_u32 v29, v30, 2, 1
    v_add_u32 v28, v30, v29
    v_add_u32 v28, 1, v28
    v_and_b32 v28, 0xfffffffc, v28
    v_lshrrev_b32 v28, 2, v28
    v_mul_u32_u24 v53, 288, v28
    v_add_u32 v53, v53, v34
    v_add_u32 v30, 0, v33
    v_bfe_u32 v29, v30, 3, 1
    v_add_u32 v28, v30, v29
    v_add_u32 v28, 3, v28
    v_and_b32 v28, 0xfffffff8, v28
    v_lshrrev_b32 v28, 3, v28
    v_add_u32 v28, 9, v28
    v_mul_u32_u24 v54, 288, v28
    v_add_u32 v54, v54, v34
    v_add_u32 v30, 16, v33
    v_bfe_u32 v29, v30, 3, 1
    v_add_u32 v28, v30, v29
    v_add_u32 v28, 3, v28
    v_and_b32 v28, 0xfffffff8, v28
    v_lshrrev_b32 v28, 3, v28
    v_add_u32 v28, 9, v28
    v_mul_u32_u24 v55, 288, v28
    v_add_u32 v55, v55, v34
    v_add_u32 v30, 32, v33
    v_bfe_u32 v29, v30, 3, 1
    v_add_u32 v28, v30, v29
    v_add_u32 v28, 3, v28
    v_and_b32 v28, 0xfffffff8, v28
    v_lshrrev_b32 v28, 3, v28
    v_add_u32 v28, 9, v28
    v_mul_u32_u24 v56, 288, v28
    v_add_u32 v56, v56, v34
    v_add_u32 v30, 48, v33
    v_bfe_u32 v29, v30, 3, 1
    v_add_u32 v28, v30, v29
    v_add_u32 v28, 3, v28
    v_and_b32 v28, 0xfffffff8, v28
    v_lshrrev_b32 v28, 3, v28
    v_add_u32 v28, 9, v28
    v_mul_u32_u24 v57, 288, v28
    v_add_u32 v57, v57, v34
    s_waitcnt lgkmcnt(0)
    ds_read_b128 v[180:183], v50 offset:0
    ds_read_b128 v[184:187], v50 offset:64
    ds_read_b128 v[188:191], v50 offset:128
    ds_read_b128 v[192:195], v50 offset:192
    ds_read_b128 v[196:199], v51 offset:0
    ds_read_b128 v[200:203], v51 offset:64
    ds_read_b128 v[204:207], v51 offset:128
    ds_read_b128 v[208:211], v51 offset:192
    s_waitcnt lgkmcnt(0)
    v_cvt_pk_bf16_f32 v45, v126, v127
    ds_write_addtid_b32 v45 offset:0
    v_pk_mul_f32 v[46:47], v[126:127], v[118:119] op_sel_hi:[1,0]
    v_pk_fma_f32 v[46:47], v[126:127], v[118:119], v[46:47] op_sel:[1,1,0] op_sel_hi:[0,1,1] neg_lo:[1,0,0]
    v_cvt_pk_bf16_f32 v44, v46, v47
    ds_write_addtid_b32 v44 offset:288
    v_pk_mul_f32 v[48:49], v[46:47], v[118:119] op_sel_hi:[1,0]
    v_pk_fma_f32 v[48:49], v[46:47], v[118:119], v[48:49] op_sel:[1,1,0] op_sel_hi:[0,1,1] neg_lo:[1,0,0]
    v_cvt_pk_bf16_f32 v45, v48, v49
    ds_write_addtid_b32 v45 offset:576
    v_pk_mul_f32 v[46:47], v[48:49], v[118:119] op_sel_hi:[1,0]
    v_pk_fma_f32 v[46:47], v[48:49], v[118:119], v[46:47] op_sel:[1,1,0] op_sel_hi:[0,1,1] neg_lo:[1,0,0]
    v_cvt_pk_bf16_f32 v44, v46, v47
    ds_write_addtid_b32 v44 offset:864
    v_pk_mul_f32 v[48:49], v[46:47], v[118:119] op_sel_hi:[1,0]
    v_pk_fma_f32 v[48:49], v[46:47], v[118:119], v[48:49] op_sel:[1,1,0] op_sel_hi:[0,1,1] neg_lo:[1,0,0]
    v_cvt_pk_bf16_f32 v45, v48, v49
    ds_write_addtid_b32 v45 offset:1152
    v_pk_mul_f32 v[46:47], v[48:49], v[118:119] op_sel_hi:[1,0]
    v_pk_fma_f32 v[46:47], v[48:49], v[118:119], v[46:47] op_sel:[1,1,0] op_sel_hi:[0,1,1] neg_lo:[1,0,0]
    v_cvt_pk_bf16_f32 v44, v46, v47
    ds_write_addtid_b32 v44 offset:1440
    v_pk_mul_f32 v[48:49], v[46:47], v[118:119] op_sel_hi:[1,0]
    v_pk_fma_f32 v[48:49], v[46:47], v[118:119], v[48:49] op_sel:[1,1,0] op_sel_hi:[0,1,1] neg_lo:[1,0,0]
    v_cvt_pk_bf16_f32 v45, v48, v49
    ds_write_addtid_b32 v45 offset:1728
    v_pk_mul_f32 v[46:47], v[48:49], v[118:119] op_sel_hi:[1,0]
    v_pk_fma_f32 v[46:47], v[48:49], v[118:119], v[46:47] op_sel:[1,1,0] op_sel_hi:[0,1,1] neg_lo:[1,0,0]
    v_cvt_pk_bf16_f32 v44, v46, v47
    ds_write_addtid_b32 v44 offset:2016
    v_pk_mul_f32 v[48:49], v[46:47], v[118:119] op_sel_hi:[1,0]
    v_pk_fma_f32 v[48:49], v[46:47], v[118:119], v[48:49] op_sel:[1,1,0] op_sel_hi:[0,1,1] neg_lo:[1,0,0]
    v_cvt_pk_bf16_f32 v45, v48, v49
    ds_write_addtid_b32 v45 offset:2304
    v_mfma_f32_16x16x32_bf16 v[60:63], v[132:135], v[180:183], 0
    v_mfma_f32_16x16x32_bf16 v[60:63], v[136:139], v[184:187], v[60:63]
    v_mfma_f32_16x16x32_bf16 v[60:63], v[140:143], v[188:191], v[60:63]
    v_mfma_f32_16x16x32_bf16 v[60:63], v[144:147], v[192:195], v[60:63]
    v_mfma_f32_16x16x32_bf16 v[64:67], v[132:135], v[196:199], 0
    v_mfma_f32_16x16x32_bf16 v[64:67], v[136:139], v[200:203], v[64:67]
    v_mfma_f32_16x16x32_bf16 v[64:67], v[140:143], v[204:207], v[64:67]
    v_mfma_f32_16x16x32_bf16 v[64:67], v[144:147], v[208:211], v[64:67]
    v_cvt_pk_bf16_f32 v44, v128, v129
    ds_write_addtid_b32 v44 offset:2592
    v_pk_mul_f32 v[46:47], v[128:129], v[120:121] op_sel_hi:[1,0]
    v_pk_fma_f32 v[46:47], v[128:129], v[120:121], v[46:47] op_sel:[1,1,0] op_sel_hi:[0,1,1] neg_lo:[1,0,0]
    v_cvt_pk_bf16_f32 v45, v46, v47
    ds_write_addtid_b32 v45 offset:2880
    v_pk_mul_f32 v[48:49], v[46:47], v[120:121] op_sel_hi:[1,0]
    v_pk_fma_f32 v[48:49], v[46:47], v[120:121], v[48:49] op_sel:[1,1,0] op_sel_hi:[0,1,1] neg_lo:[1,0,0]
    v_cvt_pk_bf16_f32 v44, v48, v49
    ds_write_addtid_b32 v44 offset:3168
    v_pk_mul_f32 v[46:47], v[48:49], v[120:121] op_sel_hi:[1,0]
    v_pk_fma_f32 v[46:47], v[48:49], v[120:121], v[46:47] op_sel:[1,1,0] op_sel_hi:[0,1,1] neg_lo:[1,0,0]
    v_cvt_pk_bf16_f32 v45, v46, v47
    ds_write_addtid_b32 v45 offset:3456
    v_pk_mul_f32 v[48:49], v[46:47], v[120:121] op_sel_hi:[1,0]
    v_pk_fma_f32 v[48:49], v[46:47], v[120:121], v[48:49] op_sel:[1,1,0] op_sel_hi:[0,1,1] neg_lo:[1,0,0]
    v_cvt_pk_bf16_f32 v44, v48, v49
    ds_write_addtid_b32 v44 offset:3744
    v_pk_mul_f32 v[46:47], v[48:49], v[120:121] op_sel_hi:[1,0]
    v_pk_fma_f32 v[46:47], v[48:49], v[120:121], v[46:47] op_sel:[1,1,0] op_sel_hi:[0,1,1] neg_lo:[1,0,0]
    v_cvt_pk_bf16_f32 v45, v46, v47
    ds_write_addtid_b32 v45 offset:4032
    v_pk_mul_f32 v[48:49], v[46:47], v[120:121] op_sel_hi:[1,0]
    v_pk_fma_f32 v[48:49], v[46:47], v[120:121], v[48:49] op_sel:[1,1,0] op_sel_hi:[0,1,1] neg_lo:[1,0,0]
    v_cvt_pk_bf16_f32 v44, v48, v49
    ds_write_addtid_b32 v44 offset:4320
    v_pk_mul_f32 v[46:47], v[48:49], v[120:121] op_sel_hi:[1,0]
    v_pk_fma_f32 v[46:47], v[48:49], v[120:121], v[46:47] op_sel:[1,1,0] op_sel_hi:[0,1,1] neg_lo:[1,0,0]
    v_cvt_pk_bf16_f32 v45, v46, v47
    ds_write_addtid_b32 v45 offset:4608
    v_pk_mul_f32 v[48:49], v[46:47], v[120:121] op_sel_hi:[1,0]
    v_pk_fma_f32 v[48:49], v[46:47], v[120:121], v[48:49] op_sel:[1,1,0] op_sel_hi:[0,1,1] neg_lo:[1,0,0]
    v_cvt_pk_bf16_f32 v44, v48, v49
    ds_write_addtid_b32 v44 offset:4896
    s_waitcnt lgkmcnt(0)
    ds_read_b128 v[180:183], v52 offset:0
    ds_read_b128 v[184:187], v52 offset:64
    ds_read_b128 v[188:191], v52 offset:128
    ds_read_b128 v[192:195], v52 offset:192
    ds_read_b128 v[196:199], v53 offset:0
    ds_read_b128 v[200:203], v53 offset:64
    ds_read_b128 v[204:207], v53 offset:128
    ds_read_b128 v[208:211], v53 offset:192
    ds_read_b128 v[212:215], v54 offset:0
    ds_read_b128 v[216:219], v54 offset:64
    ds_read_b128 v[220:223], v54 offset:128
    ds_read_b128 v[224:227], v54 offset:192
    ds_read_b128 v[228:231], v55 offset:0
    ds_read_b128 v[232:235], v55 offset:64
    ds_read_b128 v[236:239], v55 offset:128
    ds_read_b128 v[240:243], v55 offset:192
    s_waitcnt lgkmcnt(12)
    v_mfma_f32_16x16x32_bf16 v[68:71], v[148:151], v[180:183], 0
    v_mfma_f32_16x16x32_bf16 v[68:71], v[152:155], v[184:187], v[68:71]
    v_mfma_f32_16x16x32_bf16 v[68:71], v[156:159], v[188:191], v[68:71]
    v_mfma_f32_16x16x32_bf16 v[68:71], v[160:163], v[192:195], v[68:71]
    s_waitcnt lgkmcnt(8)
    v_mfma_f32_16x16x32_bf16 v[72:75], v[148:151], v[196:199], 0
    v_mfma_f32_16x16x32_bf16 v[72:75], v[152:155], v[200:203], v[72:75]
    v_mfma_f32_16x16x32_bf16 v[72:75], v[156:159], v[204:207], v[72:75]
    v_mfma_f32_16x16x32_bf16 v[72:75], v[160:163], v[208:211], v[72:75]
    s_waitcnt lgkmcnt(4)
    v_mfma_f32_16x16x32_bf16 v[76:79], v[164:167], v[212:215], 0
    v_mfma_f32_16x16x32_bf16 v[76:79], v[168:171], v[216:219], v[76:79]
    v_mfma_f32_16x16x32_bf16 v[76:79], v[172:175], v[220:223], v[76:79]
    v_mfma_f32_16x16x32_bf16 v[76:79], v[176:179], v[224:227], v[76:79]
    s_waitcnt lgkmcnt(0)
    v_mfma_f32_16x16x32_bf16 v[80:83], v[164:167], v[228:231], 0
    v_mfma_f32_16x16x32_bf16 v[80:83], v[168:171], v[232:235], v[80:83]
    v_mfma_f32_16x16x32_bf16 v[80:83], v[172:175], v[236:239], v[80:83]
    v_mfma_f32_16x16x32_bf16 v[80:83], v[176:179], v[240:243], v[80:83]
    ds_read_b128 v[180:183], v56 offset:0
    ds_read_b128 v[184:187], v56 offset:64
    ds_read_b128 v[188:191], v56 offset:128
    ds_read_b128 v[192:195], v56 offset:192
    ds_read_b128 v[196:199], v57 offset:0
    ds_read_b128 v[200:203], v57 offset:64
    ds_read_b128 v[204:207], v57 offset:128
    ds_read_b128 v[208:211], v57 offset:192
    s_waitcnt lgkmcnt(4)
    v_mfma_f32_16x16x32_bf16 v[84:87], v[164:167], v[180:183], 0
    v_mfma_f32_16x16x32_bf16 v[84:87], v[168:171], v[184:187], v[84:87]
    v_mfma_f32_16x16x32_bf16 v[84:87], v[172:175], v[188:191], v[84:87]
    v_mfma_f32_16x16x32_bf16 v[84:87], v[176:179], v[192:195], v[84:87]
    s_waitcnt lgkmcnt(0)
    v_mfma_f32_16x16x32_bf16 v[88:91], v[164:167], v[196:199], 0
    v_mfma_f32_16x16x32_bf16 v[88:91], v[168:171], v[200:203], v[88:91]
    v_mfma_f32_16x16x32_bf16 v[88:91], v[172:175], v[204:207], v[88:91]
    v_mfma_f32_16x16x32_bf16 v[88:91], v[176:179], v[208:211], v[88:91]
    s_waitcnt vmcnt(0) lgkmcnt(0)
    s_barrier
    s_setprio 0
    s_add_u32 m0, s54, 94336
    s_add_u32 s47, s52, 256
    buffer_load_dwordx4 v22, s[28:31], s47 offen lds
    s_add_u32 m0, s54, 98432
    s_add_u32 s47, s52, 33024
    buffer_load_dwordx4 v22, s[28:31], s47 offen lds
    s_add_u32 m0, s54, 102528
    s_add_u32 s47, s52, 65792
    buffer_load_dwordx4 v22, s[28:31], s47 offen lds
    s_add_u32 m0, s54, 106624
    s_add_u32 s47, s52, 98560
    buffer_load_dwordx4 v22, s[28:31], s47 offen lds
    s_add_u32 s48, s53, 458752
    s_add_u32 m0, s54, 110720
    s_nop 0
    buffer_load_dwordx4 v23, s[32:35], s48 offen lds
    s_add_u32 m0, s54, 126144
    s_nop 0
    buffer_load_dwordx4 v23, s[36:39], s48 offen lds
    s_add_u32 m0, s54, 114816
    s_nop 0
    buffer_load_dwordx4 v24, s[32:35], s48 offen lds
    s_add_u32 m0, s54, 130240
    s_nop 0
    buffer_load_dwordx4 v24, s[36:39], s48 offen lds
    s_add_u32 m0, s54, 118912
    s_nop 0
    buffer_load_dwordx4 v25, s[32:35], s48 offen lds
    s_add_u32 m0, s54, 134336
    s_nop 0
    buffer_load_dwordx4 v25, s[36:39], s48 offen lds
    s_mov_b64 exec, s[56:57]
    s_add_u32 m0, s54, 123008
    s_nop 0
    buffer_load_dwordx4 v26, s[32:35], s48 offen lds
    s_add_u32 m0, s54, 138432
    s_nop 0
    buffer_load_dwordx4 v26, s[36:39], s48 offen lds
    s_mov_b64 exec, -1
    s_barrier
    s_add_u32 m0, s54, 0
    s_add_u32 s47, s52, 384
    buffer_load_dwordx4 v22, s[28:31], s47 offen lds
    s_add_u32 m0, s54, 4096
    s_add_u32 s47, s52, 33152
    buffer_load_dwordx4 v22, s[28:31], s47 offen lds
    s_add_u32 m0, s54, 8192
    s_add_u32 s47, s52, 65920
    buffer_load_dwordx4 v22, s[28:31], s47 offen lds
    s_add_u32 m0, s54, 12288
    s_add_u32 s47, s52, 98688
    buffer_load_dwordx4 v22, s[28:31], s47 offen lds
    s_add_u32 s48, s53, 688128
    s_add_u32 m0, s54, 16384
    s_nop 0
    buffer_load_dwordx4 v23, s[32:35], s48 offen lds
    s_add_u32 m0, s54, 31808
    s_nop 0
    buffer_load_dwordx4 v23, s[36:39], s48 offen lds
    s_add_u32 m0, s54, 20480
    s_nop 0
    buffer_load_dwordx4 v24, s[32:35], s48 offen lds
    s_add_u32 m0, s54, 35904
    s_nop 0
    buffer_load_dwordx4 v24, s[36:39], s48 offen lds
    s_add_u32 m0, s54, 24576
    s_nop 0
    buffer_load_dwordx4 v25, s[32:35], s48 offen lds
    s_add_u32 m0, s54, 40000
    s_nop 0
    buffer_load_dwordx4 v25, s[36:39], s48 offen lds
    s_mov_b64 exec, s[56:57]
    s_add_u32 m0, s54, 28672
    s_nop 0
    buffer_load_dwordx4 v26, s[32:35], s48 offen lds
    s_add_u32 m0, s54, 44096
    s_nop 0
    buffer_load_dwordx4 v26, s[36:39], s48 offen lds
    s_mov_b64 exec, -1
    s_waitcnt vmcnt(12)
    s_barrier
    s_add_u32 m0, s54, 47168
    s_add_u32 s47, s52, 512
    buffer_load_dwordx4 v22, s[28:31], s47 offen lds
    s_add_u32 m0, s54, 51264
    s_add_u32 s47, s52, 33280
    buffer_load_dwordx4 v22, s[28:31], s47 offen lds
    s_add_u32 m0, s54, 55360
    s_add_u32 s47, s52, 66048
    buffer_load_dwordx4 v22, s[28:31], s47 offen lds
    s_add_u32 m0, s54, 59456
    s_add_u32 s47, s52, 98816
    buffer_load_dwordx4 v22, s[28:31], s47 offen lds
    s_add_u32 s48, s53, 917504
    s_add_u32 m0, s54, 63552
    s_nop 0
    buffer_load_dwordx4 v23, s[32:35], s48 offen lds
    s_add_u32 m0, s54, 78976
    s_nop 0
    buffer_load_dwordx4 v23, s[36:39], s48 offen lds
    s_add_u32 m0, s54, 67648
    s_nop 0
    buffer_load_dwordx4 v24, s[32:35], s48 offen lds
    s_add_u32 m0, s54, 83072
    s_nop 0
    buffer_load_dwordx4 v24, s[36:39], s48 offen lds
    s_add_u32 m0, s54, 71744
    s_nop 0
    buffer_load_dwordx4 v25, s[32:35], s48 offen lds
    s_add_u32 m0, s54, 87168
    s_nop 0
    buffer_load_dwordx4 v25, s[36:39], s48 offen lds
    s_mov_b64 exec, s[56:57]
    s_add_u32 m0, s54, 75840
    s_nop 0
    buffer_load_dwordx4 v26, s[32:35], s48 offen lds
    s_add_u32 m0, s54, 91264
    s_nop 0
    buffer_load_dwordx4 v26, s[36:39], s48 offen lds
    s_mov_b64 exec, -1
    s_waitcnt vmcnt(12)
    s_barrier
    s_add_u32 m0, s54, 94336
    s_add_u32 s47, s52, 640
    buffer_load_dwordx4 v22, s[28:31], s47 offen lds
    s_add_u32 m0, s54, 98432
    s_add_u32 s47, s52, 33408
    buffer_load_dwordx4 v22, s[28:31], s47 offen lds
    s_add_u32 m0, s54, 102528
    s_add_u32 s47, s52, 66176
    buffer_load_dwordx4 v22, s[28:31], s47 offen lds
    s_add_u32 m0, s54, 106624
    s_add_u32 s47, s52, 98944
    buffer_load_dwordx4 v22, s[28:31], s47 offen lds
    s_add_u32 s48, s53, 1146880
    s_add_u32 m0, s54, 110720
    s_nop 0
    buffer_load_dwordx4 v23, s[32:35], s48 offen lds
    s_add_u32 m0, s54, 126144
    s_nop 0
    buffer_load_dwordx4 v23, s[36:39], s48 offen lds
    s_add_u32 m0, s54, 114816
    s_nop 0
    buffer_load_dwordx4 v24, s[32:35], s48 offen lds
    s_add_u32 m0, s54, 130240
    s_nop 0
    buffer_load_dwordx4 v24, s[36:39], s48 offen lds
    s_add_u32 m0, s54, 118912
    s_nop 0
    buffer_load_dwordx4 v25, s[32:35], s48 offen lds
    s_add_u32 m0, s54, 134336
    s_nop 0
    buffer_load_dwordx4 v25, s[36:39], s48 offen lds
    s_mov_b64 exec, s[56:57]
    s_add_u32 m0, s54, 123008
    s_nop 0
    buffer_load_dwordx4 v26, s[32:35], s48 offen lds
    s_add_u32 m0, s54, 138432
    s_nop 0
    buffer_load_dwordx4 v26, s[36:39], s48 offen lds
    s_mov_b64 exec, -1
    s_waitcnt vmcnt(12)
    s_barrier
    s_add_u32 m0, s54, 0
    s_add_u32 s47, s52, 768
    buffer_load_dwordx4 v22, s[28:31], s47 offen lds
    s_add_u32 m0, s54, 4096
    s_add_u32 s47, s52, 33536
    buffer_load_dwordx4 v22, s[28:31], s47 offen lds
    s_add_u32 m0, s54, 8192
    s_add_u32 s47, s52, 66304
    buffer_load_dwordx4 v22, s[28:31], s47 offen lds
    s_add_u32 m0, s54, 12288
    s_add_u32 s47, s52, 99072
    buffer_load_dwordx4 v22, s[28:31], s47 offen lds
    s_add_u32 s48, s53, 1376256
    s_add_u32 m0, s54, 16384
    s_nop 0
    buffer_load_dwordx4 v23, s[32:35], s48 offen lds
    s_add_u32 m0, s54, 31808
    s_nop 0
    buffer_load_dwordx4 v23, s[36:39], s48 offen lds
    s_add_u32 m0, s54, 20480
    s_nop 0
    buffer_load_dwordx4 v24, s[32:35], s48 offen lds
    s_add_u32 m0, s54, 35904
    s_nop 0
    buffer_load_dwordx4 v24, s[36:39], s48 offen lds
    s_add_u32 m0, s54, 24576
    s_nop 0
    buffer_load_dwordx4 v25, s[32:35], s48 offen lds
    s_add_u32 m0, s54, 40000
    s_nop 0
    buffer_load_dwordx4 v25, s[36:39], s48 offen lds
    s_mov_b64 exec, s[56:57]
    s_add_u32 m0, s54, 28672
    s_nop 0
    buffer_load_dwordx4 v26, s[32:35], s48 offen lds
    s_add_u32 m0, s54, 44096
    s_nop 0
    buffer_load_dwordx4 v26, s[36:39], s48 offen lds
    s_mov_b64 exec, -1
    s_waitcnt vmcnt(12)
    s_barrier
    s_and_b32 s49, s2, 7
    s_lshl_b32 s49, s49, 10
    s_add_u32 s49, s49, 13729792
    s_cmp_eq_u32 s44, 0
    s_cselect_b64 vcc, -1, 0
    s_mov_b64 exec, vcc
    buffer_load_dwordx4 v[12:15], v8, s[40:43], s49 offen sc1
    s_mov_b64 exec, -1
    s_add_u32 m0, s54, 47168
    s_add_u32 s47, s52, 896
    buffer_load_dwordx4 v22, s[28:31], s47 offen lds
    s_add_u32 m0, s54, 51264
    s_add_u32 s47, s52, 33664
    buffer_load_dwordx4 v22, s[28:31], s47 offen lds
    s_add_u32 m0, s54, 55360
    s_add_u32 s47, s52, 66432
    buffer_load_dwordx4 v22, s[28:31], s47 offen lds
    s_add_u32 m0, s54, 59456
    s_add_u32 s47, s52, 99200
    buffer_load_dwordx4 v22, s[28:31], s47 offen lds
    s_add_u32 s48, s53, 1605632
    s_add_u32 m0, s54, 63552
    s_nop 0
    buffer_load_dwordx4 v23, s[32:35], s48 offen lds
    s_add_u32 m0, s54, 78976
    s_nop 0
    buffer_load_dwordx4 v23, s[36:39], s48 offen lds
    s_add_u32 m0, s54, 67648
    s_nop 0
    buffer_load_dwordx4 v24, s[32:35], s48 offen lds
    s_add_u32 m0, s54, 83072
    s_nop 0
    buffer_load_dwordx4 v24, s[36:39], s48 offen lds
    s_add_u32 m0, s54, 71744
    s_nop 0
    buffer_load_dwordx4 v25, s[32:35], s48 offen lds
    s_add_u32 m0, s54, 87168
    s_nop 0
    buffer_load_dwordx4 v25, s[36:39], s48 offen lds
    s_mov_b64 exec, s[56:57]
    s_add_u32 m0, s54, 75840
    s_nop 0
    buffer_load_dwordx4 v26, s[32:35], s48 offen lds
    s_add_u32 m0, s54, 91264
    s_nop 0
    buffer_load_dwordx4 v26, s[36:39], s48 offen lds
    s_mov_b64 exec, -1
    s_waitcnt vmcnt(12)
    s_cmp_eq_u32 s44, 0
    s_cbranch_scc0 F_PA_37
    v_xor_b32 v12, s51, v12
    v_xor_b32 v13, s51, v13
    v_xor_b32 v14, s51, v14
    v_xor_b32 v15, s51, v15
    v_or_b32 v12, v12, v13
    v_or_b32 v14, v14, v15
    v_or_b32 v12, v12, v14
    v_cmp_ne_u32 vcc, 0, v12
    s_nop 4
    s_cbranch_vccz F_PA2_38
    s_mov_b32 s47, s49
    s_mov_b32 s48, 0
    s_mov_b64 exec, -1
POLL_39:
    buffer_load_dwordx4 v[12:15], v8, s[40:43], s47 offen sc1
    s_waitcnt vmcnt(0)
    v_xor_b32 v12, s51, v12
    v_xor_b32 v13, s51, v13
    v_xor_b32 v14, s51, v14
    v_xor_b32 v15, s51, v15
    v_or_b32 v12, v12, v13
    v_or_b32 v14, v14, v15
    v_or_b32 v12, v12, v14
    v_cmp_ne_u32 vcc, 0, v12
    s_nop 4
    s_cbranch_vccz POLLD_40
    s_sleep 8
    s_add_u32 s48, s48, 1
    s_cmp_lt_u32 s48, 65536
    s_cbranch_scc1 POLL_39
POLLD_40:
    s_mov_b64 exec, -1
F_PA2_38:
    s_cmp_eq_u32 s2, 0
    s_cbranch_scc0 F_PA_37
    s_mov_b32 s47, 13697024
    v_mov_b32 v12, 0
    v_mov_b32 v13, s51
    s_mov_b64 exec, 1
    buffer_store_dword v13, v12, s[40:43], s47 offen sc1
    s_mov_b64 exec, -1
F_PA_37:
    s_barrier
    s_lshl_b32 s47, s45, 10
    s_add_u32 s47, s47, 2162688
    buffer_load_dwordx4 v[12:15], v8, s[40:43], s47 offen sc1
    s_mul_i32 s47, s46, 14336
    s_mul_i32 s48, s44, 224
    s_add_u32 s47, s47, s48
    s_add_u32 s47, s47, 2228224
    v_min_u32 v3, 55, v1
    v_lshlrev_b32 v3, 2, v3
    buffer_load_dword v33, v3, s[40:43], s47 offen offset:0 sc1
    buffer_load_dword v34, v3, s[40:43], s47 offen offset:896 sc1
    buffer_load_dword v35, v3, s[40:43], s47 offen offset:1792 sc1
    buffer_load_dword v36, v3, s[40:43], s47 offen offset:2688 sc1
    s_add_u32 s47, s47, 3584
    buffer_load_dword v37, v3, s[40:43], s47 offen offset:0 sc1
    buffer_load_dword v38, v3, s[40:43], s47 offen offset:896 sc1
    buffer_load_dword v39, v3, s[40:43], s47 offen offset:1792 sc1
    buffer_load_dword v40, v3, s[40:43], s47 offen offset:2688 sc1
    s_add_u32 s47, s47, 3584
    buffer_load_dword v41, v3, s[40:43], s47 offen offset:0 sc1
    buffer_load_dword v42, v3, s[40:43], s47 offen offset:896 sc1
    buffer_load_dword v43, v3, s[40:43], s47 offen offset:1792 sc1
    buffer_load_dword v44, v3, s[40:43], s47 offen offset:2688 sc1
    s_add_u32 s47, s47, 3584
    buffer_load_dword v45, v3, s[40:43], s47 offen offset:0 sc1
    buffer_load_dword v46, v3, s[40:43], s47 offen offset:896 sc1
    buffer_load_dword v47, v3, s[40:43], s47 offen offset:1792 sc1
    buffer_load_dword v48, v3, s[40:43], s47 offen offset:2688 sc1
    s_lshl_b32 s47, s60, 20
    s_lshl_b32 s48, s59, 4
    s_add_u32 s47, s47, s48
    s_add_u32 s47, s47, 4096
    s_add_u32 s48, s47, 524288
    v_lshlrev_b32 v2, 13, v1
    buffer_load_dwordx4 v[52:55], v2, s[40:43], s47 offen sc1
    buffer_load_dwordx4 v[56:59], v2, s[40:43], s48 offen sc1
    buffer_load_dword v7, v27, s[12:15], s24 offen
    s_add_u32 s47, s24, 8192
    s_mov_b32 exec_hi, 0xffff
    buffer_load_dword v7, v27, s[12:15], s47 offen
    s_mov_b64 exec, -1
    s_waitcnt vmcnt(21)
    s_barrier
    s_waitcnt vmcnt(4)
    v_add_f32 v33, v33, v34
    v_add_f32 v33, v33, v35
    v_add_f32 v33, v33, v36
    v_add_f32 v33, v33, v37
    v_add_f32 v33, v33, v38
    v_add_f32 v33, v33, v39
    v_add_f32 v33, v33, v40
    v_add_f32 v33, v33, v41
    v_add_f32 v33, v33, v42
    v_add_f32 v33, v33, v43
    v_add_f32 v33, v33, v44
    v_add_f32 v33, v33, v45
    v_add_f32 v33, v33, v46
    v_add_f32 v33, v33, v47
    v_add_f32 v33, v33, v48
    s_mul_i32 s47, s44, 224
    s_add_u32 s47, s47, 162816
    v_add_u32 v3, s47, v3
    ds_write_b32 v3, v33
    v_add_u32 v2, 161792, v8
    ds_write_b128 v2, v[12:15]
    s_waitcnt lgkmcnt(0)
    s_barrier
    v_mov_b32 v12, 0
    v_mov_b32 v13, 0
    v_mov_b32 v14, 0
    v_mov_b32 v15, 0
    s_cmp_eq_u32 s60, 0
    s_cbranch_scc0 F_ZU_41
    v_add_u32 v2, s55, v8
    s_mov_b64 exec, 0xffffffff
    ds_write_b128 v2, v[12:15]
    s_mov_b64 exec, -1
F_ZU_41:
    v_lshlrev_b32 v12, 4, v1
    v_add_u32 v12, s18, v12
    s_cmp_eq_u32 s60, 1
    s_cbranch_scc1 PX1_42
    s_nop 7
    ds_write_b128 v12, v[76:79] offset:0
    ds_write_b128 v12, v[80:83] offset:1024
    ds_write_b128 v12, v[84:87] offset:2048
    ds_write_b128 v12, v[88:91] offset:3072
    s_branch PX2_43
PX1_42:
    s_nop 7
    ds_write_b128 v12, v[60:63] offset:0
    ds_write_b128 v12, v[64:67] offset:1024
    ds_write_b128 v12, v[68:71] offset:2048
    ds_write_b128 v12, v[72:75] offset:3072
    v_mov_b32 v60, v76
    v_mov_b32 v61, v77
    v_mov_b32 v62, v78
    v_mov_b32 v63, v79
    v_mov_b32 v64, v80
    v_mov_b32 v65, v81
    v_mov_b32 v66, v82
    v_mov_b32 v67, v83
    v_mov_b32 v68, v84
    v_mov_b32 v69, v85
    v_mov_b32 v70, v86
    v_mov_b32 v71, v87
    v_mov_b32 v72, v88
    v_mov_b32 v73, v89
    v_mov_b32 v74, v90
    v_mov_b32 v75, v91
PX2_43:
    s_waitcnt lgkmcnt(0)
    v_mov_b32 v6, 1
    s_mov_b64 exec, 1
    ds_add_u32 v5, v6 offset:0
    s_mov_b64 exec, -1
GS_44:
    ds_read_b32 v6, v5 offset:0
    s_waitcnt lgkmcnt(0)
    v_readfirstlane_b32 s16, v6
    s_nop 0
    s_cmp_lt_u32 s16, 2
    s_cbranch_scc1 GS_44
    v_lshlrev_b32 v12, 4, v1
    v_add_u32 v12, s19, v12
    ds_read_b128 v[76:79], v12 offset:0
    ds_read_b128 v[80:83], v12 offset:1024
    ds_read_b128 v[84:87], v12 offset:2048
    ds_read_b128 v[88:91], v12 offset:3072
    s_waitcnt lgkmcnt(0)
    v_add_f32 v60, v60, v76
    v_add_f32 v61, v61, v77
    v_add_f32 v62, v62, v78
    v_add_f32 v63, v63, v79
    v_add_f32 v64, v64, v80
    v_add_f32 v65, v65, v81
    v_add_f32 v66, v66, v82
    v_add_f32 v67, v67, v83
    v_add_f32 v68, v68, v84
    v_add_f32 v69, v69, v85
    v_add_f32 v70, v70, v86
    v_add_f32 v71, v71, v87
    v_add_f32 v72, v72, v88
    v_add_f32 v73, v73, v89
    v_add_f32 v74, v74, v90
    v_add_f32 v75, v75, v91
    v_and_b32 v14, 15, v1
    v_lshrrev_b32 v13, 4, v1
    s_cmp_eq_u32 s60, 1
    s_cbranch_scc1 KW1_45
    v_mul_u32_u24 v12, 64, v13
    v_add_u32 v12, v12, v14
    v_lshlrev_b32 v12, 1, v12
    v_sub_u32 v12, s63, v12
    v_cvt_pk_bf16_f32 v16, v60, v61
    v_cvt_pk_bf16_f32 v17, v62, v63
    ds_write_b16 v12, v16 offset:4096
    ds_write_b16 v12, v16 offset:8254
    ds_write_b16_d16_hi v12, v16 offset:4064
    ds_write_b16_d16_hi v12, v16 offset:8222
    ds_write_b16 v12, v17 offset:4032
    ds_write_b16 v12, v17 offset:8190
    ds_write_b16_d16_hi v12, v17 offset:4000
    ds_write_b16_d16_hi v12, v17 offset:8158
    v_cvt_pk_bf16_f32 v18, v64, v65
    v_cvt_pk_bf16_f32 v19, v66, v67
    ds_write_b16 v12, v18 offset:3584
    ds_write_b16 v12, v18 offset:7742
    ds_write_b16_d16_hi v12, v18 offset:3552
    ds_write_b16_d16_hi v12, v18 offset:7710
    ds_write_b16 v12, v19 offset:3520
    ds_write_b16 v12, v19 offset:7678
    ds_write_b16_d16_hi v12, v19 offset:3488
    ds_write_b16_d16_hi v12, v19 offset:7646
    v_mul_u32_u24 v12, 128, v13
    v_add_u32 v12, v12, v14
    v_lshlrev_b32 v12, 1, v12
    v_sub_u32 v12, s63, v12
    v_cvt_pk_bf16_f32 v16, v68, v69
    v_cvt_pk_bf16_f32 v17, v70, v71
    ds_write_b16 v12, v16 offset:3072
    ds_write_b16 v12, v16 offset:7230
    ds_write_b16_d16_hi v12, v16 offset:3008
    ds_write_b16_d16_hi v12, v16 offset:7166
    ds_write_b16 v12, v17 offset:2944
    ds_write_b16 v12, v17 offset:7102
    ds_write_b16_d16_hi v12, v17 offset:2880
    ds_write_b16_d16_hi v12, v17 offset:7038
    v_cvt_pk_bf16_f32 v18, v72, v73
    v_cvt_pk_bf16_f32 v19, v74, v75
    ds_write_b16 v12, v18 offset:3040
    ds_write_b16 v12, v18 offset:7198
    ds_write_b16_d16_hi v12, v18 offset:2976
    ds_write_b16_d16_hi v12, v18 offset:7134
    ds_write_b16 v12, v19 offset:2912
    ds_write_b16 v12, v19 offset:7070
    ds_write_b16_d16_hi v12, v19 offset:2848
    ds_write_b16_d16_hi v12, v19 offset:7006
    s_branch KW2_46
KW1_45:
    v_mul_u32_u24 v12, 256, v13
    v_add_u32 v12, v12, v14
    v_lshlrev_b32 v12, 1, v12
    v_sub_u32 v12, s63, v12
    v_cvt_pk_bf16_f32 v16, v60, v61
    v_cvt_pk_bf16_f32 v17, v62, v63
    ds_write_b16 v12, v16 offset:2048
    ds_write_b16 v12, v16 offset:6206
    ds_write_b16_d16_hi v12, v16 offset:1920
    ds_write_b16_d16_hi v12, v16 offset:6078
    ds_write_b16 v12, v17 offset:1792
    ds_write_b16 v12, v17 offset:5950
    ds_write_b16_d16_hi v12, v17 offset:1664
    ds_write_b16_d16_hi v12, v17 offset:5822
    v_cvt_pk_bf16_f32 v18, v64, v65
    v_cvt_pk_bf16_f32 v19, v66, v67
    ds_write_b16 v12, v18 offset:2016
    ds_write_b16 v12, v18 offset:6174
    ds_write_b16_d16_hi v12, v18 offset:1888
    ds_write_b16_d16_hi v12, v18 offset:6046
    ds_write_b16 v12, v19 offset:1760
    ds_write_b16 v12, v19 offset:5918
    ds_write_b16_d16_hi v12, v19 offset:1632
    ds_write_b16_d16_hi v12, v19 offset:5790
    v_cvt_pk_bf16_f32 v16, v68, v69
    v_cvt_pk_bf16_f32 v17, v70, v71
    ds_write_b16 v12, v16 offset:1984
    ds_write_b16 v12, v16 offset:6142
    ds_write_b16_d16_hi v12, v16 offset:1856
    ds_write_b16_d16_hi v12, v16 offset:6014
    ds_write_b16 v12, v17 offset:1728
    ds_write_b16 v12, v17 offset:5886
    ds_write_b16_d16_hi v12, v17 offset:1600
    ds_write_b16_d16_hi v12, v17 offset:5758
    v_cvt_pk_bf16_f32 v18, v72, v73
    v_cvt_pk_bf16_f32 v19, v74, v75
    ds_write_b16 v12, v18 offset:1952
    ds_write_b16 v12, v18 offset:6110
    ds_write_b16_d16_hi v12, v18 offset:1824
    ds_write_b16_d16_hi v12, v18 offset:5982
    ds_write_b16 v12, v19 offset:1696
    ds_write_b16 v12, v19 offset:5854
    ds_write_b16_d16_hi v12, v19 offset:1568
    ds_write_b16_d16_hi v12, v19 offset:5726
KW2_46:
    s_waitcnt vmcnt(0)
    s_lshl_b32 s47, s60, 11
    s_add_u32 s47, s47, s55
    v_lshlrev_b32 v12, 4, v1
    v_add_u32 v12, s47, v12
    ds_write_b128 v12, v[52:55] offset:512
    ds_write_b128 v12, v[56:59] offset:1536
    s_waitcnt lgkmcnt(0)
    v_mov_b32 v6, 1
    s_mov_b64 exec, 1
    ds_add_u32 v5, v6 offset:4
    s_mov_b64 exec, -1
    v_mov_b32 v2, 163712
GS_47:
    ds_read_b32 v6, v5 offset:4
    s_waitcnt lgkmcnt(0)
    v_readfirstlane_b32 s16, v6
    s_nop 0
    s_cmp_lt_u32 s16, 2
    s_cbranch_scc1 GS_47
GS_48:
    ds_read_b32 v6, v2 offset:60
    s_waitcnt lgkmcnt(0)
    v_readfirstlane_b32 s16, v6
    s_nop 0
    s_cmp_lt_u32 s16, 4
    s_cbranch_scc1 GS_48
    v_and_b32 v15, 15, v1
    v_and_b32 v12, 1, v15
    v_add_u32 v13, v15, v12
    v_lshrrev_b32 v14, 4, v1
    v_lshlrev_b32 v14, 3, v14
    v_add_u32 v13, v13, v14
    v_sub_u32 v13, 2056, v13
    v_lshlrev_b32 v13, 1, v13
    v_mul_u32_u24 v12, 4160, v12
    v_add_u32 v13, v13, v12
    s_lshl_b32 s47, s60, 8
    s_sub_u32 s48, s63, s47
    v_add_u32 v13, s48, v13
    v_subrev_u32 v16, 704, v13
    v_subrev_u32 v17, 1728, v13
    v_subrev_u32 v18, 2752, v13
    v_subrev_u32 v19, 3776, v13
    v_lshlrev_b32 v12, 5, v15
    v_lshlrev_b32 v14, 1, v14
    v_sub_u32 v12, v12, v14
    s_sub_u32 s48, s55, s47
    s_add_u32 s48, s48, 336
    v_add_u32 v28, s48, v12
    ds_read2_b32 v[68:69], v16 offset0:176 offset1:177
    ds_read2_b32 v[70:71], v16 offset0:178 offset1:179
    ds_read_b128 v[132:135], v28 offset:192
    ds_read2_b32 v[72:73], v16 offset0:48 offset1:49
    ds_read2_b32 v[74:75], v16 offset0:50 offset1:51
    ds_read_b128 v[136:139], v28 offset:704
    ds_read2_b32 v[76:77], v17 offset0:176 offset1:177
    ds_read2_b32 v[78:79], v17 offset0:178 offset1:179
    ds_read_b128 v[140:143], v28 offset:1216
    ds_read2_b32 v[80:81], v17 offset0:48 offset1:49
    ds_read2_b32 v[82:83], v17 offset0:50 offset1:51
    ds_read_b128 v[144:147], v28 offset:1728
    ds_read2_b32 v[84:85], v18 offset0:176 offset1:177
    ds_read2_b32 v[86:87], v18 offset0:178 offset1:179
    ds_read_b128 v[148:151], v28 offset:2240
    ds_read2_b32 v[88:89], v18 offset0:48 offset1:49
    ds_read2_b32 v[90:91], v18 offset0:50 offset1:51
    ds_read_b128 v[152:155], v28 offset:2752
    ds_read2_b32 v[92:93], v19 offset0:176 offset1:177
    ds_read2_b32 v[94:95], v19 offset0:178 offset1:179
    ds_read_b128 v[156:159], v28 offset:3264
    ds_read2_b32 v[96:97], v19 offset0:48 offset1:49
    ds_read2_b32 v[98:99], v19 offset0:50 offset1:51
    ds_read_b128 v[160:163], v28 offset:3776
    s_waitcnt lgkmcnt(0)
    v_mfma_f32_16x16x32_bf16 v[36:39], v[68:71], v[132:135], 0
    ds_read2_b32 v[100:101], v16 offset0:160 offset1:161
    v_mfma_f32_16x16x32_bf16 v[40:43], v[68:71], v[136:139], 0
    ds_read2_b32 v[102:103], v16 offset0:162 offset1:163
    v_mfma_f32_16x16x32_bf16 v[40:43], v[72:75], v[132:135], v[40:43]
    ds_read_b128 v[164:167], v28 offset:128
    v_mfma_f32_16x16x32_bf16 v[44:47], v[68:71], v[140:143], 0
    ds_read2_b32 v[104:105], v16 offset0:32 offset1:33
    v_mfma_f32_16x16x32_bf16 v[44:47], v[72:75], v[136:139], v[44:47]
    ds_read2_b32 v[106:107], v16 offset0:34 offset1:35
    v_mfma_f32_16x16x32_bf16 v[44:47], v[76:79], v[132:135], v[44:47]
    ds_read_b128 v[168:171], v28 offset:640
    v_mfma_f32_16x16x32_bf16 v[48:51], v[68:71], v[144:147], 0
    ds_read2_b32 v[108:109], v17 offset0:160 offset1:161
    v_mfma_f32_16x16x32_bf16 v[48:51], v[72:75], v[140:143], v[48:51]
    ds_read2_b32 v[110:111], v17 offset0:162 offset1:163
    v_mfma_f32_16x16x32_bf16 v[48:51], v[76:79], v[136:139], v[48:51]
    ds_read_b128 v[172:175], v28 offset:1152
    v_mfma_f32_16x16x32_bf16 v[48:51], v[80:83], v[132:135], v[48:51]
    ds_read2_b32 v[112:113], v17 offset0:32 offset1:33
    v_mfma_f32_16x16x32_bf16 v[52:55], v[68:71], v[148:151], 0
    ds_read2_b32 v[114:115], v17 offset0:34 offset1:35
    v_mfma_f32_16x16x32_bf16 v[52:55], v[72:75], v[144:147], v[52:55]
    ds_read_b128 v[176:179], v28 offset:1664
    v_mfma_f32_16x16x32_bf16 v[52:55], v[76:79], v[140:143], v[52:55]
    ds_read2_b32 v[116:117], v18 offset0:160 offset1:161
    v_mfma_f32_16x16x32_bf16 v[52:55], v[80:83], v[136:139], v[52:55]
    ds_read2_b32 v[118:119], v18 offset0:162 offset1:163
    v_mfma_f32_16x16x32_bf16 v[52:55], v[84:87], v[132:135], v[52:55]
    ds_read_b128 v[180:183], v28 offset:2176
    v_mfma_f32_16x16x32_bf16 v[56:59], v[68:71], v[152:155], 0
    ds_read2_b32 v[120:121], v18 offset0:32 offset1:33
    v_mfma_f32_16x16x32_bf16 v[56:59], v[72:75], v[148:151], v[56:59]
    ds_read2_b32 v[122:123], v18 offset0:34 offset1:35
    v_mfma_f32_16x16x32_bf16 v[56:59], v[76:79], v[144:147], v[56:59]
    ds_read_b128 v[184:187], v28 offset:2688
    v_mfma_f32_16x16x32_bf16 v[56:59], v[80:83], v[140:143], v[56:59]
    ds_read2_b32 v[124:125], v19 offset0:160 offset1:161
    v_mfma_f32_16x16x32_bf16 v[56:59], v[84:87], v[136:139], v[56:59]
    ds_read2_b32 v[126:127], v19 offset0:162 offset1:163
    v_mfma_f32_16x16x32_bf16 v[56:59], v[88:91], v[132:135], v[56:59]
    ds_read_b128 v[188:191], v28 offset:3200
    v_mfma_f32_16x16x32_bf16 v[60:63], v[68:71], v[156:159], 0
    ds_read2_b32 v[128:129], v19 offset0:32 offset1:33
    v_mfma_f32_16x16x32_bf16 v[60:63], v[72:75], v[152:155], v[60:63]
    ds_read2_b32 v[130:131], v19 offset0:34 offset1:35
    v_mfma_f32_16x16x32_bf16 v[60:63], v[76:79], v[148:151], v[60:63]
    ds_read_b128 v[192:195], v28 offset:3712
    v_mfma_f32_16x16x32_bf16 v[60:63], v[80:83], v[144:147], v[60:63]
    v_mfma_f32_16x16x32_bf16 v[60:63], v[84:87], v[140:143], v[60:63]
    v_mfma_f32_16x16x32_bf16 v[60:63], v[88:91], v[136:139], v[60:63]
    v_mfma_f32_16x16x32_bf16 v[60:63], v[92:95], v[132:135], v[60:63]
    v_mfma_f32_16x16x32_bf16 v[64:67], v[68:71], v[160:163], 0
    v_mfma_f32_16x16x32_bf16 v[64:67], v[72:75], v[156:159], v[64:67]
    v_mfma_f32_16x16x32_bf16 v[64:67], v[76:79], v[152:155], v[64:67]
    v_mfma_f32_16x16x32_bf16 v[64:67], v[80:83], v[148:151], v[64:67]
    v_mfma_f32_16x16x32_bf16 v[64:67], v[84:87], v[144:147], v[64:67]
    v_mfma_f32_16x16x32_bf16 v[64:67], v[88:91], v[140:143], v[64:67]
    v_mfma_f32_16x16x32_bf16 v[64:67], v[92:95], v[136:139], v[64:67]
    v_mfma_f32_16x16x32_bf16 v[64:67], v[96:99], v[132:135], v[64:67]
    s_waitcnt lgkmcnt(0)
    v_mfma_f32_16x16x32_bf16 v[36:39], v[100:103], v[164:167], v[36:39]
    ds_read2_b32 v[68:69], v16 offset0:144 offset1:145
    v_mfma_f32_16x16x32_bf16 v[40:43], v[100:103], v[168:171], v[40:43]
    ds_read2_b32 v[70:71], v16 offset0:146 offset1:147
    v_mfma_f32_16x16x32_bf16 v[40:43], v[104:107], v[164:167], v[40:43]
    ds_read_b128 v[132:135], v28 offset:64
    v_mfma_f32_16x16x32_bf16 v[44:47], v[100:103], v[172:175], v[44:47]
    ds_read2_b32 v[72:73], v16 offset0:16 offset1:17
    v_mfma_f32_16x16x32_bf16 v[44:47], v[104:107], v[168:171], v[44:47]
    ds_read2_b32 v[74:75], v16 offset0:18 offset1:19
    v_mfma_f32_16x16x32_bf16 v[44:47], v[108:111], v[164:167], v[44:47]
    ds_read_b128 v[136:139], v28 offset:576
    v_mfma_f32_16x16x32_bf16 v[48:51], v[100:103], v[176:179], v[48:51]
    ds_read2_b32 v[76:77], v17 offset0:144 offset1:145
    v_mfma_f32_16x16x32_bf16 v[48:51], v[104:107], v[172:175], v[48:51]
    ds_read2_b32 v[78:79], v17 offset0:146 offset1:147
    v_mfma_f32_16x16x32_bf16 v[48:51], v[108:111], v[168:171], v[48:51]
    ds_read_b128 v[140:143], v28 offset:1088
    v_mfma_f32_16x16x32_bf16 v[48:51], v[112:115], v[164:167], v[48:51]
    ds_read2_b32 v[80:81], v17 offset0:16 offset1:17
    v_mfma_f32_16x16x32_bf16 v[52:55], v[100:103], v[180:183], v[52:55]
    ds_read2_b32 v[82:83], v17 offset0:18 offset1:19
    v_mfma_f32_16x16x32_bf16 v[52:55], v[104:107], v[176:179], v[52:55]
    ds_read_b128 v[144:147], v28 offset:1600
    v_mfma_f32_16x16x32_bf16 v[52:55], v[108:111], v[172:175], v[52:55]
    ds_read2_b32 v[84:85], v18 offset0:144 offset1:145
    v_mfma_f32_16x16x32_bf16 v[52:55], v[112:115], v[168:171], v[52:55]
    ds_read2_b32 v[86:87], v18 offset0:146 offset1:147
    v_mfma_f32_16x16x32_bf16 v[52:55], v[116:119], v[164:167], v[52:55]
    ds_read_b128 v[148:151], v28 offset:2112
    v_mfma_f32_16x16x32_bf16 v[56:59], v[100:103], v[184:187], v[56:59]
    ds_read2_b32 v[88:89], v18 offset0:16 offset1:17
    v_mfma_f32_16x16x32_bf16 v[56:59], v[104:107], v[180:183], v[56:59]
    ds_read2_b32 v[90:91], v18 offset0:18 offset1:19
    v_mfma_f32_16x16x32_bf16 v[56:59], v[108:111], v[176:179], v[56:59]
    ds_read_b128 v[152:155], v28 offset:2624
    v_mfma_f32_16x16x32_bf16 v[56:59], v[112:115], v[172:175], v[56:59]
    ds_read2_b32 v[92:93], v19 offset0:144 offset1:145
    v_mfma_f32_16x16x32_bf16 v[56:59], v[116:119], v[168:171], v[56:59]
    ds_read2_b32 v[94:95], v19 offset0:146 offset1:147
    v_mfma_f32_16x16x32_bf16 v[56:59], v[120:123], v[164:167], v[56:59]
    ds_read_b128 v[156:159], v28 offset:3136
    v_mfma_f32_16x16x32_bf16 v[60:63], v[100:103], v[188:191], v[60:63]
    ds_read2_b32 v[96:97], v19 offset0:16 offset1:17
    v_mfma_f32_16x16x32_bf16 v[60:63], v[104:107], v[184:187], v[60:63]
    ds_read2_b32 v[98:99], v19 offset0:18 offset1:19
    v_mfma_f32_16x16x32_bf16 v[60:63], v[108:111], v[180:183], v[60:63]
    ds_read_b128 v[160:163], v28 offset:3648
    v_mfma_f32_16x16x32_bf16 v[60:63], v[112:115], v[176:179], v[60:63]
    v_mfma_f32_16x16x32_bf16 v[60:63], v[116:119], v[172:175], v[60:63]
    v_mfma_f32_16x16x32_bf16 v[60:63], v[120:123], v[168:171], v[60:63]
    v_mfma_f32_16x16x32_bf16 v[60:63], v[124:127], v[164:167], v[60:63]
    v_mfma_f32_16x16x32_bf16 v[64:67], v[100:103], v[192:195], v[64:67]
    v_mfma_f32_16x16x32_bf16 v[64:67], v[104:107], v[188:191], v[64:67]
    v_mfma_f32_16x16x32_bf16 v[64:67], v[108:111], v[184:187], v[64:67]
    v_mfma_f32_16x16x32_bf16 v[64:67], v[112:115], v[180:183], v[64:67]
    v_mfma_f32_16x16x32_bf16 v[64:67], v[116:119], v[176:179], v[64:67]
    v_mfma_f32_16x16x32_bf16 v[64:67], v[120:123], v[172:175], v[64:67]
    v_mfma_f32_16x16x32_bf16 v[64:67], v[124:127], v[168:171], v[64:67]
    v_mfma_f32_16x16x32_bf16 v[64:67], v[128:131], v[164:167], v[64:67]
    s_waitcnt lgkmcnt(0)
    v_mfma_f32_16x16x32_bf16 v[36:39], v[68:71], v[132:135], v[36:39]
    ds_read2_b32 v[100:101], v16 offset0:128 offset1:129
    v_mfma_f32_16x16x32_bf16 v[40:43], v[68:71], v[136:139], v[40:43]
    ds_read2_b32 v[102:103], v16 offset0:130 offset1:131
    v_mfma_f32_16x16x32_bf16 v[40:43], v[72:75], v[132:135], v[40:43]
    ds_read_b128 v[164:167], v28 offset:0
    v_mfma_f32_16x16x32_bf16 v[44:47], v[68:71], v[140:143], v[44:47]
    ds_read2_b32 v[104:105], v16 offset0:0 offset1:1
    v_mfma_f32_16x16x32_bf16 v[44:47], v[72:75], v[136:139], v[44:47]
    ds_read2_b32 v[106:107], v16 offset0:2 offset1:3
    v_mfma_f32_16x16x32_bf16 v[44:47], v[76:79], v[132:135], v[44:47]
    ds_read_b128 v[168:171], v28 offset:512
    v_mfma_f32_16x16x32_bf16 v[48:51], v[68:71], v[144:147], v[48:51]
    ds_read2_b32 v[108:109], v17 offset0:128 offset1:129
    v_mfma_f32_16x16x32_bf16 v[48:51], v[72:75], v[140:143], v[48:51]
    ds_read2_b32 v[110:111], v17 offset0:130 offset1:131
    v_mfma_f32_16x16x32_bf16 v[48:51], v[76:79], v[136:139], v[48:51]
    ds_read_b128 v[172:175], v28 offset:1024
    v_mfma_f32_16x16x32_bf16 v[48:51], v[80:83], v[132:135], v[48:51]
    ds_read2_b32 v[112:113], v17 offset0:0 offset1:1
    v_mfma_f32_16x16x32_bf16 v[52:55], v[68:71], v[148:151], v[52:55]
    ds_read2_b32 v[114:115], v17 offset0:2 offset1:3
    v_mfma_f32_16x16x32_bf16 v[52:55], v[72:75], v[144:147], v[52:55]
    ds_read_b128 v[176:179], v28 offset:1536
    v_mfma_f32_16x16x32_bf16 v[52:55], v[76:79], v[140:143], v[52:55]
    ds_read2_b32 v[116:117], v18 offset0:128 offset1:129
    v_mfma_f32_16x16x32_bf16 v[52:55], v[80:83], v[136:139], v[52:55]
    ds_read2_b32 v[118:119], v18 offset0:130 offset1:131
    v_mfma_f32_16x16x32_bf16 v[52:55], v[84:87], v[132:135], v[52:55]
    ds_read_b128 v[180:183], v28 offset:2048
    v_mfma_f32_16x16x32_bf16 v[56:59], v[68:71], v[152:155], v[56:59]
    ds_read2_b32 v[120:121], v18 offset0:0 offset1:1
    v_mfma_f32_16x16x32_bf16 v[56:59], v[72:75], v[148:151], v[56:59]
    ds_read2_b32 v[122:123], v18 offset0:2 offset1:3
    v_mfma_f32_16x16x32_bf16 v[56:59], v[76:79], v[144:147], v[56:59]
    ds_read_b128 v[184:187], v28 offset:2560
    v_mfma_f32_16x16x32_bf16 v[56:59], v[80:83], v[140:143], v[56:59]
    ds_read2_b32 v[124:125], v19 offset0:128 offset1:129
    v_mfma_f32_16x16x32_bf16 v[56:59], v[84:87], v[136:139], v[56:59]
    ds_read2_b32 v[126:127], v19 offset0:130 offset1:131
    v_mfma_f32_16x16x32_bf16 v[56:59], v[88:91], v[132:135], v[56:59]
    ds_read_b128 v[188:191], v28 offset:3072
    v_mfma_f32_16x16x32_bf16 v[60:63], v[68:71], v[156:159], v[60:63]
    ds_read2_b32 v[128:129], v19 offset0:0 offset1:1
    v_mfma_f32_16x16x32_bf16 v[60:63], v[72:75], v[152:155], v[60:63]
    ds_read2_b32 v[130:131], v19 offset0:2 offset1:3
    v_mfma_f32_16x16x32_bf16 v[60:63], v[76:79], v[148:151], v[60:63]
    ds_read_b128 v[192:195], v28 offset:3584
    v_mfma_f32_16x16x32_bf16 v[60:63], v[80:83], v[144:147], v[60:63]
    v_mfma_f32_16x16x32_bf16 v[60:63], v[84:87], v[140:143], v[60:63]
    v_mfma_f32_16x16x32_bf16 v[60:63], v[88:91], v[136:139], v[60:63]
    v_mfma_f32_16x16x32_bf16 v[60:63], v[92:95], v[132:135], v[60:63]
    v_mfma_f32_16x16x32_bf16 v[64:67], v[68:71], v[160:163], v[64:67]
    v_mfma_f32_16x16x32_bf16 v[64:67], v[72:75], v[156:159], v[64:67]
    v_mfma_f32_16x16x32_bf16 v[64:67], v[76:79], v[152:155], v[64:67]
    v_mfma_f32_16x16x32_bf16 v[64:67], v[80:83], v[148:151], v[64:67]
    v_mfma_f32_16x16x32_bf16 v[64:67], v[84:87], v[144:147], v[64:67]
    v_mfma_f32_16x16x32_bf16 v[64:67], v[88:91], v[140:143], v[64:67]
    v_mfma_f32_16x16x32_bf16 v[64:67], v[92:95], v[136:139], v[64:67]
    v_mfma_f32_16x16x32_bf16 v[64:67], v[96:99], v[132:135], v[64:67]
    s_waitcnt lgkmcnt(0)
    v_mfma_f32_16x16x32_bf16 v[36:39], v[100:103], v[164:167], v[36:39]
    v_mfma_f32_16x16x32_bf16 v[40:43], v[100:103], v[168:171], v[40:43]
    v_mfma_f32_16x16x32_bf16 v[40:43], v[104:107], v[164:167], v[40:43]
    v_mfma_f32_16x16x32_bf16 v[44:47], v[100:103], v[172:175], v[44:47]
    v_mfma_f32_16x16x32_bf16 v[44:47], v[104:107], v[168:171], v[44:47]
    v_mfma_f32_16x16x32_bf16 v[44:47], v[108:111], v[164:167], v[44:47]
    v_mfma_f32_16x16x32_bf16 v[48:51], v[100:103], v[176:179], v[48:51]
    v_mfma_f32_16x16x32_bf16 v[48:51], v[104:107], v[172:175], v[48:51]
    v_mfma_f32_16x16x32_bf16 v[48:51], v[108:111], v[168:171], v[48:51]
    v_mfma_f32_16x16x32_bf16 v[48:51], v[112:115], v[164:167], v[48:51]
    v_mfma_f32_16x16x32_bf16 v[52:55], v[100:103], v[180:183], v[52:55]
    v_mfma_f32_16x16x32_bf16 v[52:55], v[104:107], v[176:179], v[52:55]
    v_mfma_f32_16x16x32_bf16 v[52:55], v[108:111], v[172:175], v[52:55]
    v_mfma_f32_16x16x32_bf16 v[52:55], v[112:115], v[168:171], v[52:55]
    v_mfma_f32_16x16x32_bf16 v[52:55], v[116:119], v[164:167], v[52:55]
    v_mfma_f32_16x16x32_bf16 v[56:59], v[100:103], v[184:187], v[56:59]
    v_mfma_f32_16x16x32_bf16 v[56:59], v[104:107], v[180:183], v[56:59]
    v_mfma_f32_16x16x32_bf16 v[56:59], v[108:111], v[176:179], v[56:59]
    v_mfma_f32_16x16x32_bf16 v[56:59], v[112:115], v[172:175], v[56:59]
    v_mfma_f32_16x16x32_bf16 v[56:59], v[116:119], v[168:171], v[56:59]
    v_mfma_f32_16x16x32_bf16 v[56:59], v[120:123], v[164:167], v[56:59]
    v_mfma_f32_16x16x32_bf16 v[60:63], v[100:103], v[188:191], v[60:63]
    v_mfma_f32_16x16x32_bf16 v[60:63], v[104:107], v[184:187], v[60:63]
    v_mfma_f32_16x16x32_bf16 v[60:63], v[108:111], v[180:183], v[60:63]
    v_mfma_f32_16x16x32_bf16 v[60:63], v[112:115], v[176:179], v[60:63]
    v_mfma_f32_16x16x32_bf16 v[60:63], v[116:119], v[172:175], v[60:63]
    v_mfma_f32_16x16x32_bf16 v[60:63], v[120:123], v[168:171], v[60:63]
    v_mfma_f32_16x16x32_bf16 v[60:63], v[124:127], v[164:167], v[60:63]
    v_mfma_f32_16x16x32_bf16 v[64:67], v[100:103], v[192:195], v[64:67]
    v_mfma_f32_16x16x32_bf16 v[64:67], v[104:107], v[188:191], v[64:67]
    v_mfma_f32_16x16x32_bf16 v[64:67], v[108:111], v[184:187], v[64:67]
    v_mfma_f32_16x16x32_bf16 v[64:67], v[112:115], v[180:183], v[64:67]
    v_mfma_f32_16x16x32_bf16 v[64:67], v[116:119], v[176:179], v[64:67]
    v_mfma_f32_16x16x32_bf16 v[64:67], v[120:123], v[172:175], v[64:67]
    v_mfma_f32_16x16x32_bf16 v[64:67], v[124:127], v[168:171], v[64:67]
    v_mfma_f32_16x16x32_bf16 v[64:67], v[128:131], v[164:167], v[64:67]
    v_lshlrev_b32 v12, 4, v1
    v_add_u32 v12, s18, v12
    s_cmp_eq_u32 s60, 1
    s_cbranch_scc1 PX1_49
    s_nop 7
    ds_write_b128 v12, v[52:55] offset:0
    ds_write_b128 v12, v[56:59] offset:1024
    ds_write_b128 v12, v[60:63] offset:2048
    ds_write_b128 v12, v[64:67] offset:3072
    s_branch PX2_50
PX1_49:
    s_nop 7
    ds_write_b128 v12, v[36:39] offset:0
    ds_write_b128 v12, v[40:43] offset:1024
    ds_write_b128 v12, v[44:47] offset:2048
    ds_write_b128 v12, v[48:51] offset:3072
    v_mov_b32 v36, v52
    v_mov_b32 v37, v53
    v_mov_b32 v38, v54
    v_mov_b32 v39, v55
    v_mov_b32 v40, v56
    v_mov_b32 v41, v57
    v_mov_b32 v42, v58
    v_mov_b32 v43, v59
    v_mov_b32 v44, v60
    v_mov_b32 v45, v61
    v_mov_b32 v46, v62
    v_mov_b32 v47, v63
    v_mov_b32 v48, v64
    v_mov_b32 v49, v65
    v_mov_b32 v50, v66
    v_mov_b32 v51, v67
PX2_50:
    s_waitcnt lgkmcnt(0)
    v_mov_b32 v6, 1
    s_mov_b64 exec, 1
    ds_add_u32 v5, v6 offset:8
    s_mov_b64 exec, -1
GS_51:
    ds_read_b32 v6, v5 offset:8
    s_waitcnt lgkmcnt(0)
    v_readfirstlane_b32 s16, v6
    s_nop 0
    s_cmp_lt_u32 s16, 2
    s_cbranch_scc1 GS_51
    v_lshlrev_b32 v12, 4, v1
    v_add_u32 v12, s19, v12
    ds_read_b128 v[52:55], v12 offset:0
    ds_read_b128 v[56:59], v12 offset:1024
    ds_read_b128 v[60:63], v12 offset:2048
    ds_read_b128 v[64:67], v12 offset:3072
    s_waitcnt lgkmcnt(0)
    v_add_f32 v36, v36, v52
    v_add_f32 v37, v37, v53
    v_add_f32 v38, v38, v54
    v_add_f32 v39, v39, v55
    v_add_f32 v40, v40, v56
    v_add_f32 v41, v41, v57
    v_add_f32 v42, v42, v58
    v_add_f32 v43, v43, v59
    v_add_f32 v44, v44, v60
    v_add_f32 v45, v45, v61
    v_add_f32 v46, v46, v62
    v_add_f32 v47, v47, v63
    v_add_f32 v48, v48, v64
    v_add_f32 v49, v49, v65
    v_add_f32 v50, v50, v66
    v_add_f32 v51, v51, v67
    v_and_b32 v14, 15, v1
    s_lshl_b32 s47, s60, 11
    v_lshlrev_b32 v12, 5, v14
    v_lshrrev_b32 v13, 4, v1
    v_lshlrev_b32 v13, 3, v13
    v_add_u32 v12, v12, v13
    s_add_u32 s48, s47, s55
    v_add_u32 v13, s48, v12
    ds_read_b64 v[68:69], v13 offset:512
    ds_read_b64 v[70:71], v13 offset:1024
    ds_read_b64 v[72:73], v13 offset:1536
    ds_read_b64 v[74:75], v13 offset:2048
    s_lshl_b32 s48, s59, 12
    s_add_u32 s48, s48, s47
    s_add_u32 s48, s48, 11534336
    s_waitcnt lgkmcnt(0)
    v_cvt_pk_bf16_f32 v76, v36, v37
    v_cvt_pk_bf16_f32 v77, v38, v39
    v_lshlrev_b32 v36, 16, v76
    v_and_b32 v37, s50, v76
    v_lshlrev_b32 v78, 16, v68
    v_and_b32 v79, s50, v68
    v_lshlrev_b32 v38, 16, v77
    v_and_b32 v39, s50, v77
    v_lshlrev_b32 v80, 16, v69
    v_and_b32 v81, s50, v69
    v_mul_f32 v78, v78, v32
    v_mul_f32 v79, v79, v32
    v_mul_f32 v80, v80, v32
    v_mul_f32 v81, v81, v32
    v_cvt_pk_bf16_f32 v76, v78, v79
    v_cvt_pk_bf16_f32 v77, v80, v81
    v_lshlrev_b32 v78, 16, v76
    v_and_b32 v79, s50, v76
    v_lshlrev_b32 v80, 16, v77
    v_and_b32 v81, s50, v77
    v_add_f32 v36, v36, v78
    v_add_f32 v37, v37, v79
    v_add_f32 v38, v38, v80
    v_add_f32 v39, v39, v81
    v_cvt_pk_bf16_f32 v88, v36, v37
    v_cvt_pk_bf16_f32 v89, v38, v39
    buffer_store_dwordx2 v[88:89], v12, s[40:43], s48 offen offset:0 sc1
    v_cvt_pk_bf16_f32 v82, v40, v41
    v_cvt_pk_bf16_f32 v83, v42, v43
    v_lshlrev_b32 v40, 16, v82
    v_and_b32 v41, s50, v82
    v_lshlrev_b32 v84, 16, v70
    v_and_b32 v85, s50, v70
    v_lshlrev_b32 v42, 16, v83
    v_and_b32 v43, s50, v83
    v_lshlrev_b32 v86, 16, v71
    v_and_b32 v87, s50, v71
    v_mul_f32 v84, v84, v32
    v_mul_f32 v85, v85, v32
    v_mul_f32 v86, v86, v32
    v_mul_f32 v87, v87, v32
    v_cvt_pk_bf16_f32 v82, v84, v85
    v_cvt_pk_bf16_f32 v83, v86, v87
    v_lshlrev_b32 v84, 16, v82
    v_and_b32 v85, s50, v82
    v_lshlrev_b32 v86, 16, v83
    v_and_b32 v87, s50, v83
    v_add_f32 v40, v40, v84
    v_add_f32 v41, v41, v85
    v_add_f32 v42, v42, v86
    v_add_f32 v43, v43, v87
    v_cvt_pk_bf16_f32 v90, v40, v41
    v_cvt_pk_bf16_f32 v91, v42, v43
    buffer_store_dwordx2 v[90:91], v12, s[40:43], s48 offen offset:512 sc1
    v_cvt_pk_bf16_f32 v76, v44, v45
    v_cvt_pk_bf16_f32 v77, v46, v47
    v_lshlrev_b32 v44, 16, v76
    v_and_b32 v45, s50, v76
    v_lshlrev_b32 v78, 16, v72
    v_and_b32 v79, s50, v72
    v_lshlrev_b32 v46, 16, v77
    v_and_b32 v47, s50, v77
    v_lshlrev_b32 v80, 16, v73
    v_and_b32 v81, s50, v73
    v_mul_f32 v78, v78, v32
    v_mul_f32 v79, v79, v32
    v_mul_f32 v80, v80, v32
    v_mul_f32 v81, v81, v32
    v_cvt_pk_bf16_f32 v76, v78, v79
    v_cvt_pk_bf16_f32 v77, v80, v81
    v_lshlrev_b32 v78, 16, v76
    v_and_b32 v79, s50, v76
    v_lshlrev_b32 v80, 16, v77
    v_and_b32 v81, s50, v77
    v_add_f32 v44, v44, v78
    v_add_f32 v45, v45, v79
    v_add_f32 v46, v46, v80
    v_add_f32 v47, v47, v81
    v_cvt_pk_bf16_f32 v92, v44, v45
    v_cvt_pk_bf16_f32 v93, v46, v47
    buffer_store_dwordx2 v[92:93], v12, s[40:43], s48 offen offset:1024 sc1
    v_cvt_pk_bf16_f32 v82, v48, v49
    v_cvt_pk_bf16_f32 v83, v50, v51
    v_lshlrev_b32 v48, 16, v82
    v_and_b32 v49, s50, v82
    v_lshlrev_b32 v84, 16, v74
    v_and_b32 v85, s50, v74
    v_lshlrev_b32 v50, 16, v83
    v_and_b32 v51, s50, v83
    v_lshlrev_b32 v86, 16, v75
    v_and_b32 v87, s50, v75
    v_mul_f32 v84, v84, v32
    v_mul_f32 v85, v85, v32
    v_mul_f32 v86, v86, v32
    v_mul_f32 v87, v87, v32
    v_cvt_pk_bf16_f32 v82, v84, v85
    v_cvt_pk_bf16_f32 v83, v86, v87
    v_lshlrev_b32 v84, 16, v82
    v_and_b32 v85, s50, v82
    v_lshlrev_b32 v86, 16, v83
    v_and_b32 v87, s50, v83
    v_add_f32 v48, v48, v84
    v_add_f32 v49, v49, v85
    v_add_f32 v50, v50, v86
    v_add_f32 v51, v51, v87
    v_cvt_pk_bf16_f32 v94, v48, v49
    v_cvt_pk_bf16_f32 v95, v50, v51
    buffer_store_dwordx2 v[94:95], v12, s[40:43], s48 offen offset:1536 sc1
    s_waitcnt vmcnt(0)
    v_mov_b32 v5, 163712
    v_mov_b32 v12, 1
    s_mov_b64 exec, 1
    ds_add_rtn_u32 v13, v5, v12 offset:32
    s_waitcnt lgkmcnt(0)
    v_readfirstlane_b32 s47, v13
    s_mov_b64 exec, -1
    s_cmp_eq_u32 s47, 3
    s_cbranch_scc0 F_PC_52
    s_and_b32 s47, s2, 7
    s_lshl_b32 s47, s47, 9
    s_lshr_b32 s48, s2, 5
    s_lshl_b32 s48, s48, 6
    s_add_u32 s47, s47, s48
    s_bfe_u32 s48, s2, 131075
    s_lshl_b32 s48, s48, 2
    s_add_u32 s47, s47, s48
    s_add_u32 s47, s47, 13713408
    v_mov_b32 v12, 0
    v_mov_b32 v13, s51
    s_mov_b64 exec, 1
    buffer_store_dword v13, v12, s[40:43], s47 offen sc1
    s_mov_b64 exec, -1
F_PC_52:
    s_cmp_eq_u32 s44, 99
    s_cbranch_scc0 F_QC_53
    v_lshrrev_b32 v3, 2, v1
    v_lshlrev_b32 v3, 6, v3
    v_and_b32 v2, 3, v1
    v_lshl_add_u32 v3, v2, 2, v3
    s_lshr_b32 s47, s2, 5
    s_lshl_b32 s47, s47, 9
    s_add_u32 s47, s47, 13713408
    s_mov_b32 s48, 0
    s_mov_b64 exec, 0xffffffff
POLL_54:
    buffer_load_dword v12, v3, s[40:43], s47 offen sc1
    s_waitcnt vmcnt(0)
    v_cmp_ne_u32 vcc, s51, v12
    s_nop 4
    s_cbranch_vccz POLLD_55
    s_sleep 4
    s_add_u32 s48, s48, 1
    s_cmp_lt_u32 s48, 65536
    s_cbranch_scc1 POLL_54
POLLD_55:
    s_mov_b64 exec, -1
    v_mov_b32 v6, 1
    s_mov_b64 exec, 1
    ds_add_u32 v5, v6 offset:56
    s_mov_b64 exec, -1
F_QC_53:
F_END:
    s_endpgm
F_CODE_END:
    s_endpgm
.section .rodata,"a"
.p2align 6
.amdhsa_kernel recurrent_scan__ssm_conv_s4__swiglu_ffn__prompt_kernel
  .amdhsa_next_free_vgpr 252
  .amdhsa_next_free_sgpr 72
  .amdhsa_accum_offset 252
  .amdhsa_group_segment_fixed_size 0
  .amdhsa_kernarg_size 128
  .amdhsa_user_sgpr_count 2
  .amdhsa_user_sgpr_kernarg_segment_ptr 1
  .amdhsa_system_sgpr_workgroup_id_x 1
  .amdhsa_float_denorm_mode_32 3
.end_amdhsa_kernel
```
